```python
import torch

def _softmax(x, axis=-1):
    return torch.softmax(x, dim=axis)
def _gelu(x):
    return torch.nn.functional.gelu(x, approximate="tanh")
def _silu(x):
    return torch.nn.functional.silu(x)
def _sigmoid(x):
    return torch.sigmoid(x)
def _layernorm(x, axis=-1, eps=1e-5):
    m = x.mean(dim=axis, keepdim=True)
    v = x.var(dim=axis, keepdim=True, unbiased=False)
    return (x - m) / torch.sqrt(v + eps)
def _scatter_add(tgt, idx, src, axis=0):
    return tgt.clone().index_add_(axis, idx, src)
def _segment_sum(src, seg, n):
    out = torch.zeros((n,) + src.shape[1:], dtype=src.dtype)
    return out.index_add_(0, seg, src)
def _pad(x, pw):
    flat = tuple(v for pair in reversed(pw) for v in pair)
    return torch.nn.functional.pad(x, flat)

kernel_name = 'recurrent_scan__ssm_conv_s4__glu_gated_glu__prompt'

def setup_inputs():

    _w = (lambda a: (lambda t: t.to(torch.bfloat16) if t.is_floating_point() else t)(torch.as_tensor(a)))
    def _A_setup():
        B, L, D, N = 1, 2048, 512, 128
        A_re = -(lambda _x: torch.exp(torch.as_tensor(_x)))((lambda *s: torch.randn(*s, dtype=torch.bfloat16) * 6.4)(D, N))
        A_im = torch.pi * (lambda *s: torch.randn(*s, dtype=torch.bfloat16) * 0.05)(D, N)
        B_re = (lambda *s: torch.randn(*s, dtype=torch.bfloat16) * 0.1)(D, N)
        B_im = (lambda *s: torch.randn(*s, dtype=torch.bfloat16) * 0.1)(D, N)
        C_re = (lambda *s: torch.randn(*s, dtype=torch.bfloat16) * 0.1)(D, N)
        C_im = (lambda *s: torch.randn(*s, dtype=torch.bfloat16) * 0.1)(D, N)
        log_dt = (lambda *s: torch.randn(*s, dtype=torch.bfloat16) * 0.05)(D) * 0.5 - 4.0
        Dskip = (lambda *s: torch.randn(*s, dtype=torch.bfloat16) * 0.05)(D)
        return {
            "u": _w((lambda *s: torch.randn(*s, dtype=torch.bfloat16) * 0.05)(B, L, D)),
            "A_re": _w(A_re),
            "A_im": _w(A_im),
            "B_re": _w(B_re),
            "B_im": _w(B_im),
            "C_re": _w(C_re),
            "C_im": _w(C_im),
            "log_dt": _w(log_dt),
            "Dskip": _w(Dskip),
        }
    _A_in = _A_setup()

    def _B_setup():
        B, S, D, F = 1, 2048, 512, 1376
        return {
            "x": _w((lambda *s: torch.randn(*s, dtype=torch.bfloat16) * 0.05)(B, S, D)),
            "w_gate": _w((lambda *s: torch.randn(*s, dtype=torch.bfloat16) * 0.05)(D, F)),
            "w_up": _w((lambda *s: torch.randn(*s, dtype=torch.bfloat16) * 0.05)(D, F)),
            "w_down": _w((lambda *s: torch.randn(*s, dtype=torch.bfloat16) * 0.05)(F, D)),
        }
    _B_in = _B_setup()

    return {
        "A_u": _A_in["u"],
        "A_A_re": _A_in["A_re"],
        "A_A_im": _A_in["A_im"],
        "A_B_re": _A_in["B_re"],
        "A_B_im": _A_in["B_im"],
        "A_C_re": _A_in["C_re"],
        "A_C_im": _A_in["C_im"],
        "A_log_dt": _A_in["log_dt"],
        "A_Dskip": _A_in["Dskip"],
        "B_x": _B_in["x"],
        "B_w_gate": _B_in["w_gate"],
        "B_w_up": _B_in["w_up"],
        "B_w_down": _B_in["w_down"],
    }

def reference(A_u, A_A_re, A_A_im, A_B_re, A_B_im, A_C_re, A_C_im, A_log_dt, A_Dskip, B_x, B_w_gate, B_w_up, B_w_down):
    def _A_ref(u, A_re, A_im, B_re, B_im, C_re, C_im, log_dt, Dskip):
        Bsz, L, D = u.shape
        dt = torch.exp(log_dt)[:, None]
        A = A_re + 1j * A_im
        Bc = B_re + 1j * B_im
        Cc = C_re + 1j * C_im
        logdA = dt * A
        dB = dt * Bc
        l = (lambda x, dt: x.to(dt))(torch.arange(L), A_re.dtype)
        P = torch.exp(logdA[:, :, None] * l[None, None, :])
        K = torch.einsum("dn,dnl,dn->dl", Cc, P, dB).real
        L2 = 2 * L
        Kp = _pad(K, ((0, 0), (0, L)))
        up = (lambda x, *d: x.permute(*d))(u, 0, 2, 1)
        up = _pad(up, ((0, 0), (0, 0), (0, L)))
        Kf = (lambda x, axes=(-2,-1): torch.fft.rfft2(x.float(), dim=axes))(Kp[:, None, :], axes=(-2, -1))
        Uf = (lambda x, axes=(-2,-1): torch.fft.rfft2(x.float(), dim=axes))(up[:, :, None, :], axes=(-2, -1))
        Yf = Uf * Kf[None, :, :, :]
        y = (lambda x, s, axes=(-2,-1): torch.fft.irfft2(x, s=s, dim=axes).to(torch.bfloat16))(Yf, (1, L2), axes=(-2, -1))[:, :, 0, :L]
        y = (lambda x, *d: x.permute(*d))(y, 0, 2, 1) + u * Dskip[None, None, :]
        return y

    def _B_ref(x, w_gate, w_up, w_down):
        g = torch.einsum("bsd,df->bsf", x, w_gate)
        u = torch.einsum("bsd,df->bsf", x, w_up)
        h = _sigmoid(g) * u
        return torch.einsum("bsf,fd->bsd", h, w_down)

    x = A_u
    xn = _layernorm(x, axis=-1)
    s = _A_ref(xn, A_A_re, A_A_im, A_B_re, A_B_im, A_C_re, A_C_im, A_log_dt, A_Dskip)
    g = _silu(_B_ref(xn, B_w_gate, B_w_up, B_w_down))
    return x + s * g
```

```asm
; @launch grid=(256,1,1) block=(512,1,1) lds=163840
.amdgcn_target "amdgcn-amd-amdhsa--gfx950"
.text
.globl recurrent_scan__ssm_conv_s4__glu_gated_glu__prompt_kernel
.p2align 8
.type recurrent_scan__ssm_conv_s4__glu_gated_glu__prompt_kernel,@function
recurrent_scan__ssm_conv_s4__glu_gated_glu__prompt_kernel:
    s_cmp_ge_u32 s2, 256
    s_cbranch_scc1 L_exit
    s_load_dwordx16 s[4:19], s[0:1], 0
    s_load_dwordx16 s[20:35], s[0:1], 64
    v_lshrrev_b32 v2, 6, v0
    v_and_b32 v1, 63, v0
    v_readfirstlane_b32 s52, v2
    s_lshr_b32 s96, s2, 3
    s_and_b32 s58, s2, 6
    s_mul_i32 s59, s58, 14
    s_add_u32 s59, s59, s96
    s_and_b32 s60, s96, 30
    s_lshl2_add_u32 s60, s60, s58
    s_and_b32 s61, s96, 1
    s_add_u32 s60, s60, s61
    s_cmp_lt_u32 s96, 28
    s_cselect_b32 s59, s59, s60
    s_and_b32 s53, s59, 7
    s_lshr_b32 s54, s59, 3
    s_and_b32 s58, s2, 1
    s_lshl3_add_u32 s53, s58, s53
    s_cmp_lt_u32 s52, 4
    s_cbranch_scc1 L_help
    s_getpc_b64 s[98:99]
L_pc:
    s_sub_u32 s98, s98, L_pc-recurrent_scan__ssm_conv_s4__glu_gated_glu__prompt_kernel+512
    s_subb_u32 s99, s99, 0
    s_lshl2_add_u32 s59, s96, s52
    s_lshl_b32 s59, s59, 7
    v_and_b32 v4, 1, v1
    v_lshl_add_u32 v4, v4, 14, s59
    v_min_u32 v4, L_exit-recurrent_scan__ssm_conv_s4__glu_gated_glu__prompt_kernel+512, v4
    global_load_dword v183, v4, s[98:99]
    s_lshl4_add_u32 s58, s53, s54
    s_lshl2_add_u32 s58, s58, s52
    s_lshl_b32 s58, s58, 11
    s_sub_u32 s58, s58, 8192
    v_lshl_add_u32 v219, v1, 4, s58
    s_and_b32 s59, s2, 7
    s_lshr_b32 s60, s96, 3
    s_lshl2_add_u32 s55, s59, s60
    s_and_b32 s56, s96, 7
    s_lshl_b32 s57, s59, 6
    s_lshl1_add_u32 s57, s96, s57
    v_mov_b32 v3, 163712
    v_and_b32 v4, 15, v0
    v_lshl_add_u32 v4, v4, 2, v3
    v_mov_b32 v5, 0
    ds_write_b32 v4, v5
    s_waitcnt lgkmcnt(0)
    global_load_dwordx4 v[184:187], v219, s[4:5]
    global_load_dwordx4 v[188:191], v219, s[4:5] offset:1024
    s_add_u32 s98, s34, 10649600
    s_addc_u32 s99, s35, 0
    s_load_dwordx2 s[100:101], s[98:99], 0
    s_branch L_gemm
L_help:
    s_setprio 3
    v_lshrrev_b32 v8, 3, v1
    v_and_b32 v9, 7, v1
    v_lshrrev_b32 v34, 4, v1
    v_xor_b32 v9, v9, v34
    s_lshl2_add_u32 s58, s53, s52
    s_lshl_b32 s58, s58, 15
    v_lshl_add_u32 v160, v8, 10, s58
    v_lshl_add_u32 v160, v9, 4, v160
    v_xor_b32 v11, 64, v160
    v_add_u32 v161, 7168, v11
    v_add_u32 v162, 14336, v160
    v_add_u32 v163, 21504, v11
    s_lshl_b32 s68, s52, 12
    s_mul_i32 s48, s53, 4
    s_mul_i32 s58, s54, 4
    s_add_u32 s48, s48, s58
    s_lshr_b32 s58, s2, 1
    s_xor_b32 s58, s58, s2
    s_and_b32 s58, s58, 1
    s_mul_i32 s58, s58, 2
    s_add_u32 s48, s48, s58
    s_mov_b32 s39, 0x20000
    s_cmp_eq_u32 s54, 15
    s_cselect_b32 s38, 0, 2097152
    s_and_b32 s62, s52, 1
    s_lshr_b32 s63, s52, 1
    s_and_b32 s48, s48, 7
    s_mov_b32 m0, s68
    s_lshl_b32 s65, s48, 7
    s_mul_i32 s67, s48, 176128
    s_mul_i32 s58, s54, 192
    s_sub_i32 s59, 2752, s58
    s_mul_i32 s60, s63, 88064
    s_add_u32 s58, s58, s60
    s_and_b32 s61, s54, 1
    v_bfrev_b32 v12, 1
    v_mov_b32 v8, v1
    v_mul_u32_u24 v9, 21846, v8
    v_lshrrev_b32 v9, 18, v9
    v_mul_u32_u24 v10, 12, v9
    v_sub_u32 v8, v8, v10
    v_lshlrev_b32 v8, 4, v8
    v_cmp_gt_i32 vcc, s59, v8
    v_mul_u32_u24 v9, 2752, v9
    v_add3_u32 v9, v9, v8, s58
    v_cndmask_b32 v9, v12, v9, vcc
    v_subrev_u32 v164, 0, v9
    v_add_u32 v167, 44032, v164
    s_waitcnt lgkmcnt(0)
    s_mov_b32 s36, s4
    s_mov_b32 s37, s5
    buffer_load_dwordx4 v160, s[36:39], s65 offen offset:0 lds
    buffer_load_dwordx4 v161, s[36:39], s65 offen offset:1024 lds
    buffer_load_dwordx4 v162, s[36:39], s65 offen offset:2048 lds
    buffer_load_dwordx4 v163, s[36:39], s65 offen offset:3072 lds
    v_add_u32 v8, 64, v1
    v_mul_u32_u24 v9, 21846, v8
    v_lshrrev_b32 v9, 18, v9
    v_mul_u32_u24 v10, 12, v9
    v_sub_u32 v8, v8, v10
    v_lshlrev_b32 v8, 4, v8
    v_cmp_gt_i32 vcc, s59, v8
    v_mul_u32_u24 v9, 2752, v9
    v_add3_u32 v9, v9, v8, s58
    v_cndmask_b32 v9, v12, v9, vcc
    v_subrev_u32 v165, 1024, v9
    v_add_u32 v168, 44032, v165
    v_add_u32 v8, 128, v1
    v_mul_u32_u24 v9, 21846, v8
    v_lshrrev_b32 v9, 18, v9
    v_mul_u32_u24 v10, 12, v9
    v_sub_u32 v8, v8, v10
    v_lshlrev_b32 v8, 4, v8
    v_cmp_gt_i32 vcc, s59, v8
    v_mul_u32_u24 v9, 2752, v9
    v_add3_u32 v9, v9, v8, s58
    v_cndmask_b32 v9, v12, v9, vcc
    v_subrev_u32 v166, 2048, v9
    v_add_u32 v169, 44032, v166
    s_mul_i32 s69, s62, 12320
    s_mul_i32 s58, s63, 6144
    s_add_u32 s69, s69, s58
    s_add_u32 s69, s69, 16384
    s_mov_b32 s42, 1409024
    s_mov_b32 s43, 0x20000
    s_cmp_eq_u32 s62, 0
    s_cselect_b32 s40, s24, s26
    s_cselect_b32 s41, s25, s27
    s_mov_b32 m0, s69
    s_add_u32 s48, s48, 1
    buffer_load_dwordx4 v164, s[40:43], s67 offen offset:0 lds
    buffer_load_dwordx4 v165, s[40:43], s67 offen offset:1024 lds
    buffer_load_dwordx4 v166, s[40:43], s67 offen offset:2048 lds
    s_add_u32 m0, s69, 3072
    s_add_u32 s68, s68, 41088
    buffer_load_dwordx4 v167, s[40:43], s67 offen offset:0 lds
    buffer_load_dwordx4 v168, s[40:43], s67 offen offset:1024 lds
    buffer_load_dwordx4 v169, s[40:43], s67 offen offset:2048 lds
    s_add_u32 s69, s69, 41088
    s_cmp_lt_u32 s68, 123264
    s_cselect_b32 s97, 0, 123264
    s_sub_u32 s68, s68, s97
    s_sub_u32 s69, s69, s97
    s_and_b32 s59, s2, 7
    s_lshr_b32 s60, s96, 3
    s_lshl2_add_u32 s55, s59, s60
    s_and_b32 s56, s96, 7
    s_lshl_b32 s57, s59, 6
    s_lshl1_add_u32 s57, s96, s57
    v_mov_b32 v3, 163712
    s_mul_i32 s64, s62, 14592
    s_add_u32 s64, s64, 123264
    s_add_u32 s59, s57, s62
    s_lshl_b32 s59, s59, 1
    v_mov_b32 v7, s59
    s_add_u32 s59, s59, s63
    s_lshl_b32 s59, s59, 7
    v_lshl_add_u32 v6, v1, 1, s59
    s_lshl_b32 s3, s52, 8
    s_add_u32 s3, s3, s2
    v_lshrrev_b32 v8, 3, v1
    v_and_b32 v9, 7, v1
    v_bfe_u32 v10, v1, 4, 1
    v_lshlrev_b32 v11, 2, v10
    v_xor_b32 v9, v9, v11
    s_lshr_b32 s58, s3, 3
    s_lshl_b32 s58, s58, 14
    s_and_b32 s59, s3, 7
    s_lshl_b32 s59, s59, 7
    s_add_u32 s58, s58, s59
    v_lshl_add_u32 v8, v8, 10, s58
    v_lshl_add_u32 v8, v9, 4, v8
    v_add_u32 v9, 7168, v8
    s_mov_b32 s44, s28
    s_mov_b32 s45, s29
    s_mov_b32 s46, 1409024
    s_mov_b32 s47, 0x20000
    s_lshl_b32 s58, s63, 11
    s_add_u32 m0, s58, s64
    s_add_u32 s58, s58, s64
    buffer_load_dwordx4 v8, s[44:47], 0 offen lds
    buffer_load_dwordx4 v9, s[44:47], 0 offen offset:1024 lds
    s_and_b32 s48, s48, 7
    s_mov_b32 m0, s68
    s_lshl_b32 s65, s48, 7
    s_mul_i32 s67, s48, 176128
    v_bfe_u32 v8, v1, 2, 2
    v_lshrrev_b32 v9, 5, v1
    v_lshl_add_u32 v9, v9, 2, v8
    v_lshlrev_b32 v9, 7, v9
    v_lshrrev_b32 v8, 1, v8
    v_lshl_add_u32 v9, v8, 6, v9
    buffer_load_dwordx4 v160, s[36:39], s65 offen offset:0 lds
    v_lshl_add_u32 v9, v10, 5, v9
    v_and_b32 v8, 3, v1
    v_lshl_add_u32 v9, v8, 3, v9
    v_xor_b32 v8, 64, v9
    v_add_u32 v4, s58, v9
    v_add_u32 v5, s58, v8
    buffer_load_dwordx4 v161, s[36:39], s65 offen offset:1024 lds
    s_add_u32 s44, s34, 11534336
    s_addc_u32 s45, s35, 0
    s_mov_b32 s46, 1441792
    s_lshl_b32 s3, s3, 11
    v_lshl_add_u32 v2, v1, 4, s3
    s_lshl_b32 s49, s53, 4
    s_add_u32 s49, s49, s54
    buffer_load_dwordx4 v162, s[36:39], s65 offen offset:2048 lds
    v_bfe_u32 v57, v1, 2, 2
    v_mul_u32_u24 v57, 1088, v57
    v_lshl_add_u32 v57, v34, 5, v57
    v_and_b32 v58, 3, v1
    v_lshl_add_u32 v57, v58, 3, v57
    s_lshl_b32 s59, s52, 8
    buffer_load_dwordx4 v163, s[36:39], s65 offen offset:3072 lds
    s_mov_b32 m0, s69
    s_add_u32 s48, s48, 1
    s_add_u32 s59, s59, 152448
    v_add_u32 v57, s59, v57
    s_lshl_b32 s58, s49, 13
    s_lshl_b32 s59, s52, 11
    s_add_u32 s58, s58, s59
    s_add_u32 s58, s58, 6291456
    buffer_load_dwordx4 v164, s[40:43], s67 offen offset:0 lds
    v_lshl_add_u32 v56, v1, 4, s58
    s_lshl3_add_u32 s60, s55, s56
    s_lshl_b32 s51, s60, 7
    s_lshl_b32 s58, s49, 7
    s_cmp_eq_u32 s63, 0
    s_cselect_b32 s58, s58, s51
    s_cmp_eq_u32 s52, 0
    s_cselect_b32 s59, 64, 0
    buffer_load_dwordx4 v165, s[40:43], s67 offen offset:1024 lds
    s_lshl_b32 s61, s52, 15
    s_add_u32 s58, s58, s61
    s_add_u32 s58, s58, 10485760
    v_lshl_add_u32 v55, v1, 4, s58
    v_and_b32 v54, 1, v1
    v_lshl_add_u32 v54, v54, 4, s59
    buffer_load_dwordx4 v166, s[40:43], s67 offen offset:2048 lds
    s_add_u32 m0, s69, 3072
    s_add_u32 s68, s68, 41088
    v_add_u32 v54, v54, v3
    v_and_b32 v52, 31, v1
    s_lshl_b32 s22, s49, 7
    s_add_u32 s22, s22, 10518528
    v_mov_b32 v38, s22
    v_mov_b32 v39, 1
    buffer_load_dwordx4 v167, s[40:43], s67 offen offset:0 lds
    s_mul_i32 s22, s52, 9216
    s_add_u32 s22, s22, 82176
    v_and_b32 v59, 1, v34
    v_lshlrev_b32 v59, 5, v59
    v_lshl_add_u32 v59, v58, 3, v59
    v_lshrrev_b32 v53, 5, v1
    buffer_load_dwordx4 v168, s[40:43], s67 offen offset:1024 lds
    v_bfe_u32 v35, v1, 2, 2
    v_lshl_add_u32 v35, v53, 2, v35
    v_mul_u32_u24 v35, 144, v35
    v_add3_u32 v59, v59, v35, s22
    v_lshl_add_u32 v15, v58, 3, s64
    v_mul_u32_u24 v58, 144, v1
    buffer_load_dwordx4 v169, s[40:43], s67 offen offset:2048 lds
    s_add_u32 s69, s69, 41088
    s_cmp_lt_u32 s68, 123264
    s_cselect_b32 s97, 0, 123264
    s_sub_u32 s68, s68, s97
    s_sub_u32 s69, s69, s97
    v_add_u32 v58, s22, v58
    v_lshrrev_b32 v35, 1, v1
    v_and_b32 v36, 1, v1
    s_lshl_b32 s22, s52, 19
    s_lshl_b32 s23, s57, 4
    s_add_u32 s22, s22, s23
    s_add_u32 s22, s22, 6291456
    v_lshl_add_u32 v48, v35, 13, s22
    v_lshl_add_u32 v48, v36, 4, v48
    v_add_u32 v49, 0x40000, v48
    s_lshl_b32 s22, s52, 10
    s_add_u32 s22, s22, 132224
    v_mul_u32_u24 v60, 14592, v36
    v_lshl_add_u32 v60, v35, 4, v60
    v_add_u32 v60, s22, v60
    s_lshl_b32 s22, s52, 7
    v_lshl_add_u32 v61, v52, 2, s22
    s_lshl2_add_u32 s22, s53, s52
    s_lshl_b32 s22, s22, 9
    s_add_u32 s22, s22, 10485760
    v_and_b32 v50, 7, v1
    v_lshl_add_u32 v50, v50, 2, s22
    v_and_b32 v35, 24, v1
    v_lshl_add_u32 v50, v35, 4, v50
    v_lshlrev_b32 v61, 2, v61
    v_add_u32 v61, 161664, v61
    s_lshr_b32 s23, s52, 2
    s_and_b32 s22, s52, 1
    s_lshl1_add_u32 s22, s23, s22
    s_lshl2_add_u32 s22, s55, s22
    s_lshl_b32 s22, s22, 14
    s_lshl_b32 s23, s56, 7
    s_add_u32 s22, s22, s23
    s_and_b32 s23, s52, 2
    s_lshl_b32 s23, s23, 5
    s_add_u32 s22, s22, s23
    v_and_b32 v191, 15, v1
    v_lshl_add_u32 v191, v191, 10, s22
    v_and_b32 v35, 48, v1
    v_add_u32 v191, v191, v35
    v_lshl_add_u32 v14, s52, 2, v3
    v_lshl_add_u32 v13, s62, 2, v3
    v_lshl_add_u32 v12, v1, 4, s64
    v_lshl_add_u32 v63, v1, 3, s64
    s_add_u32 s23, s64, 13056
    v_lshlrev_b32 v187, 4, v52
    v_lshl_add_u32 v187, v53, 3, v187
    v_add_u32 v187, s23, v187
    v_sub_u32 v188, 3, v53
    v_lshlrev_b32 v188, v188, v52
    v_lshl_add_u32 v188, v53, 8, v188
    v_add_u32 v188, s23, v188
    v_mul_u32_u24 v189, 124, v53
    v_add_u32 v189, v188, v189
    v_lshlrev_b32 v190, 1, v52
    v_lshl_add_u32 v190, v53, 8, v190
    v_add_u32 v190, s23, v190
    s_lshl_b32 s22, s63, 6
    v_add_u32 v33, s22, v1
    v_lshlrev_b32 v32, 4, v33
    v_cvt_f32_u32 v32, v32
    v_lshrrev_b32 v35, 23, v32
    v_max_u32 v35, 134, v35
    v_subrev_u32 v35, 134, v35
    v_sub_u32 v36, 127, v35
    v_lshlrev_b32 v36, 23, v36
    v_lshlrev_b32 v35, 7, v35
    v_add_u32 v35, 0x4b000000, v35
    v_fmac_f32 v35, v32, v36
    v_lshl_add_u32 v37, v33, 5, s64
    s_add_u32 s23, s23, 0x6a000000
    v_lshl_add_u32 v170, v35, 1, s23
    v_fmamk_f32 v171, v36, 0x3f800000, v35
    v_lshl_add_u32 v171, v171, 1, s23
    v_fmamk_f32 v172, v36, 0x40000000, v35
    v_lshl_add_u32 v172, v172, 1, s23
    v_fmamk_f32 v173, v36, 0x40400000, v35
    v_lshl_add_u32 v173, v173, 1, s23
    v_fmamk_f32 v174, v36, 0x40800000, v35
    v_lshl_add_u32 v174, v174, 1, s23
    v_fmamk_f32 v175, v36, 0x40a00000, v35
    v_lshl_add_u32 v175, v175, 1, s23
    v_fmamk_f32 v176, v36, 0x40c00000, v35
    s_waitcnt vmcnt(12)
    s_barrier
    s_setprio 0
    ds_read_b128 v[104:107], v54
    ds_read_b64_tr_b16 v[96:97], v57 offset:0
    ds_read_b64_tr_b16 v[98:99], v57 offset:4352
    ds_read_b64_tr_b16 v[100:101], v57 offset:128
    ds_read_b64_tr_b16 v[102:103], v57 offset:4480
    s_waitcnt vmcnt(10)
    ds_read_b64_tr_b16 v[68:69], v4
    ds_read_b64_tr_b16 v[70:71], v4 offset:1024
    ds_read_b64_tr_b16 v[72:73], v5
    ds_read_b64_tr_b16 v[74:75], v5 offset:1024
    s_waitcnt lgkmcnt(6)
    global_store_dwordx4 v56, v[96:99], s[34:35] sc1
    s_waitcnt lgkmcnt(4)
    global_store_dwordx4 v56, v[100:103], s[34:35] offset:1024 sc1
    s_mov_b64 exec, 0xff
    global_store_dwordx4 v55, v[104:107], s[34:35] sc1
    s_mov_b64 exec, -1
    s_waitcnt lgkmcnt(2)
    buffer_store_dwordx4 v[68:71], v2, s[44:47], 0 offen sc1
    s_waitcnt lgkmcnt(0)
    buffer_store_dwordx4 v[72:75], v2, s[44:47], 0 offen offset:1024 sc1
    global_load_short_d16_hi v46, v7, s[18:19]
    global_load_short_d16_hi v108, v6, s[6:7]
    global_load_short_d16_hi v109, v6, s[8:9]
    global_load_short_d16_hi v110, v6, s[10:11]
    global_load_short_d16_hi v111, v6, s[12:13]
    global_load_short_d16_hi v112, v6, s[14:15]
    global_load_short_d16_hi v113, v6, s[16:17]
    global_load_short_d16_hi v47, v7, s[20:21]
    s_and_b32 s48, s48, 7
    s_mov_b32 m0, s68
    s_lshl_b32 s65, s48, 7
    s_mul_i32 s67, s48, 176128
    v_lshl_add_u32 v176, v176, 1, s23
    buffer_load_dwordx4 v160, s[36:39], s65 offen offset:0 lds
    v_fmamk_f32 v177, v36, 0x40e00000, v35
    buffer_load_dwordx4 v161, s[36:39], s65 offen offset:1024 lds
    v_lshl_add_u32 v177, v177, 1, s23
    buffer_load_dwordx4 v162, s[36:39], s65 offen offset:2048 lds
    v_fmamk_f32 v178, v36, 0x41000000, v35
    buffer_load_dwordx4 v163, s[36:39], s65 offen offset:3072 lds
    s_mov_b32 m0, s69
    s_add_u32 s48, s48, 1
    v_lshl_add_u32 v178, v178, 1, s23
    buffer_load_dwordx4 v164, s[40:43], s67 offen offset:0 lds
    v_fmamk_f32 v179, v36, 0x41100000, v35
    buffer_load_dwordx4 v165, s[40:43], s67 offen offset:1024 lds
    v_lshl_add_u32 v179, v179, 1, s23
    buffer_load_dwordx4 v166, s[40:43], s67 offen offset:2048 lds
    s_add_u32 m0, s69, 3072
    s_add_u32 s68, s68, 41088
    v_fmamk_f32 v180, v36, 0x41200000, v35
    buffer_load_dwordx4 v167, s[40:43], s67 offen offset:0 lds
    v_lshl_add_u32 v180, v180, 1, s23
    buffer_load_dwordx4 v168, s[40:43], s67 offen offset:1024 lds
    v_fmamk_f32 v181, v36, 0x41300000, v35
    buffer_load_dwordx4 v169, s[40:43], s67 offen offset:2048 lds
    s_add_u32 s69, s69, 41088
    s_cmp_lt_u32 s68, 123264
    s_cselect_b32 s97, 0, 123264
    s_sub_u32 s68, s68, s97
    s_sub_u32 s69, s69, s97
    v_lshl_add_u32 v181, v181, 1, s23
    v_fmamk_f32 v182, v36, 0x41400000, v35
    v_lshl_add_u32 v182, v182, 1, s23
    v_fmamk_f32 v183, v36, 0x41500000, v35
    v_lshl_add_u32 v183, v183, 1, s23
    v_fmamk_f32 v184, v36, 0x41600000, v35
    v_lshl_add_u32 v184, v184, 1, s23
    v_fmamk_f32 v185, v36, 0x41700000, v35
    v_lshl_add_u32 v185, v185, 1, s23
    v_fmamk_f32 v186, v36, 0x41800000, v35
    s_waitcnt vmcnt(18)
    s_barrier
    s_and_b32 s48, s48, 7
    s_mov_b32 m0, s68
    s_lshl_b32 s65, s48, 7
    s_mul_i32 s67, s48, 176128
    v_lshl_add_u32 v186, v186, 1, s23
    v_and_b32 v33, 15, v1
    v_add_u32 v35, 1, v33
    v_lshrrev_b32 v36, 1, v35
    v_lshl_add_u32 v36, v34, 2, v36
    v_and_b32 v35, 1, v35
    v_mul_u32_u24 v35, 4160, v35
    buffer_load_dwordx4 v160, s[36:39], s65 offen offset:0 lds
    v_lshl_add_u32 v36, v36, 2, v35
    s_lshl_b32 s22, s63, 8
    s_add_u32 s23, s22, s64
    v_add_u32 v40, s23, v36
    v_add_u32 v41, 1024, v40
    v_add_u32 v42, 2048, v40
    v_add_u32 v43, 3072, v40
    buffer_load_dwordx4 v161, s[36:39], s65 offen offset:1024 lds
    v_lshlrev_b32 v44, 1, v33
    v_sub_u32 v44, v44, v34
    s_sub_u32 s23, s64, s22
    s_add_u32 s23, s23, 8976
    v_lshl_add_u32 v44, v44, 4, s23
    v_min_u32 v45, 1, v1
    v_cvt_f32_u32 v45, v45
    buffer_load_dwordx4 v162, s[36:39], s65 offen offset:2048 lds
    v_sub_f32 v45, 1.0, v45
    v_mov_b32 v128, 0
    v_mov_b32 v129, 0
    v_mov_b32 v130, 0
    v_mov_b32 v131, 0
    v_mov_b32 v132, 0
    v_mov_b32 v133, 0
    buffer_load_dwordx4 v163, s[36:39], s65 offen offset:3072 lds
    s_mov_b32 m0, s69
    s_add_u32 s48, s48, 1
    v_mov_b32 v134, 0
    v_mov_b32 v135, 0
    v_mov_b32 v136, 0
    v_mov_b32 v137, 0
    v_mov_b32 v138, 0
    v_mov_b32 v139, 0
    v_mov_b32 v140, 0
    buffer_load_dwordx4 v164, s[40:43], s67 offen offset:0 lds
    v_mov_b32 v141, 0
    v_mov_b32 v142, 0
    v_mov_b32 v143, 0
    v_mov_b32 v144, 0
    v_mov_b32 v145, 0
    v_mov_b32 v146, 0
    v_mov_b32 v147, 0
    buffer_load_dwordx4 v165, s[40:43], s67 offen offset:1024 lds
    v_mov_b32 v148, 0
    v_mov_b32 v149, 0
    v_mov_b32 v150, 0
    v_mov_b32 v151, 0
    v_mov_b32 v152, 0
    v_mov_b32 v153, 0
    v_mov_b32 v154, 0
    buffer_load_dwordx4 v166, s[40:43], s67 offen offset:2048 lds
    s_add_u32 m0, s69, 3072
    s_add_u32 s68, s68, 41088
    v_mov_b32 v155, 0
    v_mov_b32 v156, 0
    v_mov_b32 v157, 0
    v_mov_b32 v158, 0
    v_mov_b32 v159, 0
    s_mul_i32 s23, s52, 30720
    s_add_u32 s23, s23, 22528
    buffer_load_dwordx4 v167, s[40:43], s67 offen offset:0 lds
    v_lshl_add_u32 v16, v1, 4, s23
    s_xor_b32 s22, s52, 2
    s_mul_i32 s22, s22, 30720
    s_add_u32 s22, s22, 22528
    v_lshl_add_u32 v17, v1, 4, s22
    v_lshl_add_u32 v22, v33, 5, s22
    v_lshl_add_u32 v22, v34, 3, v22
    buffer_load_dwordx4 v168, s[40:43], s67 offen offset:1024 lds
    s_add_u32 s22, s57, s62
    s_lshl_b32 s22, s22, 1
    s_add_u32 s22, s22, s63
    s_lshl_b32 s22, s22, 11
    s_add_u32 s22, s22, 8388608
    v_lshl_add_u32 v21, v1, 4, s22
    s_and_b32 s22, s2, 7
    buffer_load_dwordx4 v169, s[40:43], s67 offen offset:2048 lds
    s_add_u32 s69, s69, 41088
    s_cmp_lt_u32 s68, 123264
    s_cselect_b32 s97, 0, 123264
    s_sub_u32 s68, s68, s97
    s_sub_u32 s69, s69, s97
    s_lshl_b32 s22, s22, 7
    s_add_u32 s22, s22, 10584064
    v_lshl_add_u32 v24, v1, 10, s22
    s_add_u32 s22, s51, 10584064
    v_mov_b32 v23, s22
    v_lshrrev_b32 v35, 3, v1
    v_and_b32 v36, 7, v1
    s_lshl_b32 s22, s62, 1
    s_add_u32 s22, s22, s63
    s_lshl_b32 s23, s56, 2
    s_waitcnt vmcnt(10)
    s_barrier
    s_and_b32 s48, s48, 7
    s_mov_b32 m0, s68
    s_lshl_b32 s65, s48, 7
    s_mul_i32 s67, s48, 176128
    s_add_u32 s22, s22, s23
    s_lshl_b32 s22, s22, 16
    s_lshl_b32 s23, s55, 7
    s_add_u32 s22, s22, s23
    s_add_u32 s22, s22, 8388608
    v_lshl_add_u32 v18, v35, 12, s22
    v_lshl_add_u32 v18, v36, 4, v18
    buffer_load_dwordx4 v160, s[36:39], s65 offen offset:0 lds
    v_add_u32 v19, 0x8000, v18
    s_mul_i32 s22, s63, 2304
    s_add_u32 s22, s22, s64
    v_mul_u32_u24 v20, 144, v35
    v_lshl_add_u32 v20, v36, 4, v20
    v_add_u32 v20, s22, v20
    v_mov_b32 v26, 0
    buffer_load_dwordx4 v161, s[36:39], s65 offen offset:1024 lds
    v_mov_b32 v27, 0
    v_mov_b32 v28, 1
    v_mov_b32 v29, 2
    v_mov_b32 v30, 3
    s_waitcnt vmcnt(22)
    v_mul_f32 v46, 0x3fb8aa3b, v46
    v_exp_f32 v46, v46
    buffer_load_dwordx4 v162, s[36:39], s65 offen offset:2048 lds
    s_nop 0
    v_cvt_pk_bf16_f32 v46, v46, v46
    v_lshlrev_b32 v46, 16, v46
    v_mul_f32 v64, v46, v108
    v_mul_f32 v65, v46, v109
    v_mul_f32 v110, v46, v110
    v_mul_f32 v111, v46, v111
    buffer_load_dwordx4 v163, s[36:39], s65 offen offset:3072 lds
    s_mov_b32 m0, s69
    s_add_u32 s48, s48, 1
    v_mul_f32 v64, 0x3fb8aa3b, v64
    v_mul_f32 v65, 0x3e22f983, v65
    v_mul_f32 v80, v112, v110
    v_mul_f32 v81, v112, v111
    v_fma_f32 v80, -v113, v111, v80
    v_fma_f32 v81, -v113, v110, -v81
    v_mul_f32 v67, 0x41000000, v65
    buffer_load_dwordx4 v164, s[40:43], s67 offen offset:0 lds
    v_mul_f32 v66, 0x41000000, v64
    v_fract_f32 v67, v67
    v_exp_f32 v66, v66
    v_cos_f32 v117, v67
    v_sin_f32 v118, v67
    v_mul_f32 v117, v66, v117
    v_mul_f32 v118, v66, v118
    buffer_load_dwordx4 v165, s[40:43], s67 offen offset:1024 lds
    v_sub_f32 v119, 0, v118
    v_fract_f32 v67, v65
    v_exp_f32 v66, v64
    v_cos_f32 v114, v67
    v_sin_f32 v115, v67
    v_mul_f32 v114, v66, v114
    v_mul_f32 v115, v66, v115
    buffer_load_dwordx4 v166, s[40:43], s67 offen offset:2048 lds
    s_add_u32 m0, s69, 3072
    s_add_u32 s68, s68, 41088
    v_sub_f32 v116, 0, v115
    v_mul_f32 v67, 0x43800000, v65
    v_mul_f32 v66, 0x43800000, v64
    v_fract_f32 v67, v67
    v_exp_f32 v66, v66
    v_cos_f32 v120, v67
    v_sin_f32 v121, v67
    buffer_load_dwordx4 v167, s[40:43], s67 offen offset:0 lds
    v_mul_f32 v120, v66, v120
    v_mul_f32 v121, v66, v121
    v_sub_f32 v122, 0, v121
    v_cvt_pk_bf16_f32 v192, 1.0, v117
    v_cvt_pk_bf16_f32 v196, 0, v118
    v_mul_f32 v124, v117, v117
    v_mul_f32 v125, v117, v118
    buffer_load_dwordx4 v168, s[40:43], s67 offen offset:1024 lds
    v_fmac_f32 v124, v118, v119
    v_fmac_f32 v125, v118, v117
    v_mul_f32 v126, v124, v117
    v_mul_f32 v127, v124, v118
    v_fmac_f32 v126, v125, v119
    v_fmac_f32 v127, v125, v117
    v_cvt_pk_bf16_f32 v193, v124, v126
    buffer_load_dwordx4 v169, s[40:43], s67 offen offset:2048 lds
    s_add_u32 s69, s69, 41088
    s_cmp_lt_u32 s68, 123264
    s_cselect_b32 s97, 0, 123264
    s_sub_u32 s68, s68, s97
    s_sub_u32 s69, s69, s97
    v_cvt_pk_bf16_f32 v197, v125, v127
    v_mul_f32 v124, v126, v117
    v_mul_f32 v125, v126, v118
    v_fmac_f32 v124, v127, v119
    v_fmac_f32 v125, v127, v117
    v_mul_f32 v126, v124, v117
    v_mul_f32 v127, v124, v118
    v_fmac_f32 v126, v125, v119
    v_fmac_f32 v127, v125, v117
    v_cvt_pk_bf16_f32 v194, v124, v126
    s_waitcnt vmcnt(10)
    s_barrier
    s_and_b32 s48, s48, 7
    s_mov_b32 m0, s68
    s_lshl_b32 s65, s48, 7
    s_mul_i32 s67, s48, 176128
    v_cvt_pk_bf16_f32 v198, v125, v127
    v_mul_f32 v124, v126, v117
    v_mul_f32 v125, v126, v118
    v_fmac_f32 v124, v127, v119
    v_fmac_f32 v125, v127, v117
    v_mul_f32 v126, v124, v117
    v_mul_f32 v127, v124, v118
    buffer_load_dwordx4 v160, s[36:39], s65 offen offset:0 lds
    v_fmac_f32 v126, v125, v119
    v_fmac_f32 v127, v125, v117
    v_cvt_pk_bf16_f32 v195, v124, v126
    v_cvt_pk_bf16_f32 v199, v125, v127
    v_mul_f32 v124, v126, v117
    v_mul_f32 v125, v126, v118
    v_fmac_f32 v124, v127, v119
    buffer_load_dwordx4 v161, s[36:39], s65 offen offset:1024 lds
    v_fmac_f32 v125, v127, v117
    v_mul_f32 v126, v124, v117
    v_mul_f32 v127, v124, v118
    v_fmac_f32 v126, v125, v119
    v_fmac_f32 v127, v125, v117
    v_cvt_pk_bf16_f32 v200, v124, v126
    v_cvt_pk_bf16_f32 v204, v125, v127
    buffer_load_dwordx4 v162, s[36:39], s65 offen offset:2048 lds
    v_mul_f32 v124, v126, v117
    v_mul_f32 v125, v126, v118
    v_fmac_f32 v124, v127, v119
    v_fmac_f32 v125, v127, v117
    v_mul_f32 v126, v124, v117
    v_mul_f32 v127, v124, v118
    v_fmac_f32 v126, v125, v119
    buffer_load_dwordx4 v163, s[36:39], s65 offen offset:3072 lds
    s_mov_b32 m0, s69
    s_add_u32 s48, s48, 1
    v_fmac_f32 v127, v125, v117
    v_cvt_pk_bf16_f32 v201, v124, v126
    v_cvt_pk_bf16_f32 v205, v125, v127
    v_mul_f32 v124, v126, v117
    v_mul_f32 v125, v126, v118
    v_fmac_f32 v124, v127, v119
    v_fmac_f32 v125, v127, v117
    buffer_load_dwordx4 v164, s[40:43], s67 offen offset:0 lds
    v_mul_f32 v126, v124, v117
    v_mul_f32 v127, v124, v118
    v_fmac_f32 v126, v125, v119
    v_fmac_f32 v127, v125, v117
    v_cvt_pk_bf16_f32 v202, v124, v126
    v_cvt_pk_bf16_f32 v206, v125, v127
    v_mul_f32 v124, v126, v117
    buffer_load_dwordx4 v165, s[40:43], s67 offen offset:1024 lds
    v_mul_f32 v125, v126, v118
    v_fmac_f32 v124, v127, v119
    v_fmac_f32 v125, v127, v117
    v_mul_f32 v126, v124, v117
    v_mul_f32 v127, v124, v118
    v_fmac_f32 v126, v125, v119
    v_fmac_f32 v127, v125, v117
    buffer_load_dwordx4 v166, s[40:43], s67 offen offset:2048 lds
    s_add_u32 m0, s69, 3072
    s_add_u32 s68, s68, 41088
    v_cvt_pk_bf16_f32 v203, v124, v126
    v_cvt_pk_bf16_f32 v207, v125, v127
    v_mul_f32 v124, v126, v117
    v_mul_f32 v125, v126, v118
    v_fmac_f32 v124, v127, v119
    v_fmac_f32 v125, v127, v117
    v_mul_f32 v126, v124, v117
    buffer_load_dwordx4 v167, s[40:43], s67 offen offset:0 lds
    v_mul_f32 v127, v124, v118
    v_fmac_f32 v126, v125, v119
    v_fmac_f32 v127, v125, v117
    v_cvt_pk_bf16_f32 v208, v124, v126
    v_cvt_pk_bf16_f32 v212, v125, v127
    v_mul_f32 v124, v126, v117
    v_mul_f32 v125, v126, v118
    buffer_load_dwordx4 v168, s[40:43], s67 offen offset:1024 lds
    v_fmac_f32 v124, v127, v119
    v_fmac_f32 v125, v127, v117
    v_mul_f32 v126, v124, v117
    v_mul_f32 v127, v124, v118
    v_fmac_f32 v126, v125, v119
    v_fmac_f32 v127, v125, v117
    v_cvt_pk_bf16_f32 v209, v124, v126
    buffer_load_dwordx4 v169, s[40:43], s67 offen offset:2048 lds
    s_add_u32 s69, s69, 41088
    s_cmp_lt_u32 s68, 123264
    s_cselect_b32 s97, 0, 123264
    s_sub_u32 s68, s68, s97
    s_sub_u32 s69, s69, s97
    v_cvt_pk_bf16_f32 v213, v125, v127
    v_mul_f32 v124, v126, v117
    v_mul_f32 v125, v126, v118
    v_fmac_f32 v124, v127, v119
    v_fmac_f32 v125, v127, v117
    v_mul_f32 v126, v124, v117
    v_mul_f32 v127, v124, v118
    v_fmac_f32 v126, v125, v119
    v_fmac_f32 v127, v125, v117
    v_cvt_pk_bf16_f32 v210, v124, v126
    s_waitcnt vmcnt(10)
    s_barrier
    s_and_b32 s48, s48, 7
    s_mov_b32 m0, s68
    s_lshl_b32 s65, s48, 7
    s_mul_i32 s67, s48, 176128
    v_cvt_pk_bf16_f32 v214, v125, v127
    v_mul_f32 v124, v126, v117
    v_mul_f32 v125, v126, v118
    v_fmac_f32 v124, v127, v119
    v_fmac_f32 v125, v127, v117
    v_mul_f32 v126, v124, v117
    v_mul_f32 v127, v124, v118
    buffer_load_dwordx4 v160, s[36:39], s65 offen offset:0 lds
    v_fmac_f32 v126, v125, v119
    v_fmac_f32 v127, v125, v117
    v_cvt_pk_bf16_f32 v211, v124, v126
    v_cvt_pk_bf16_f32 v215, v125, v127
    v_mul_f32 v124, v126, v117
    v_mul_f32 v125, v126, v118
    v_fmac_f32 v124, v127, v119
    buffer_load_dwordx4 v161, s[36:39], s65 offen offset:1024 lds
    v_fmac_f32 v125, v127, v117
    v_mul_f32 v126, v124, v117
    v_mul_f32 v127, v124, v118
    v_fmac_f32 v126, v125, v119
    v_fmac_f32 v127, v125, v117
    v_cvt_pk_bf16_f32 v216, v124, v126
    v_cvt_pk_bf16_f32 v220, v125, v127
    buffer_load_dwordx4 v162, s[36:39], s65 offen offset:2048 lds
    v_mul_f32 v124, v126, v117
    v_mul_f32 v125, v126, v118
    v_fmac_f32 v124, v127, v119
    v_fmac_f32 v125, v127, v117
    v_mul_f32 v126, v124, v117
    v_mul_f32 v127, v124, v118
    v_fmac_f32 v126, v125, v119
    buffer_load_dwordx4 v163, s[36:39], s65 offen offset:3072 lds
    s_mov_b32 m0, s69
    s_add_u32 s48, s48, 1
    v_fmac_f32 v127, v125, v117
    v_cvt_pk_bf16_f32 v217, v124, v126
    v_cvt_pk_bf16_f32 v221, v125, v127
    v_mul_f32 v124, v126, v117
    v_mul_f32 v125, v126, v118
    v_fmac_f32 v124, v127, v119
    v_fmac_f32 v125, v127, v117
    buffer_load_dwordx4 v164, s[40:43], s67 offen offset:0 lds
    v_mul_f32 v126, v124, v117
    v_mul_f32 v127, v124, v118
    v_fmac_f32 v126, v125, v119
    v_fmac_f32 v127, v125, v117
    v_cvt_pk_bf16_f32 v218, v124, v126
    v_cvt_pk_bf16_f32 v222, v125, v127
    v_mul_f32 v124, v126, v117
    buffer_load_dwordx4 v165, s[40:43], s67 offen offset:1024 lds
    v_mul_f32 v125, v126, v118
    v_fmac_f32 v124, v127, v119
    v_fmac_f32 v125, v127, v117
    v_mul_f32 v126, v124, v117
    v_mul_f32 v127, v124, v118
    v_fmac_f32 v126, v125, v119
    v_fmac_f32 v127, v125, v117
    buffer_load_dwordx4 v166, s[40:43], s67 offen offset:2048 lds
    s_add_u32 m0, s69, 3072
    s_add_u32 s68, s68, 41088
    v_cvt_pk_bf16_f32 v219, v124, v126
    v_cvt_pk_bf16_f32 v223, v125, v127
    v_mul_f32 v82, v80, v114
    v_mul_f32 v83, v80, v116
    v_fmac_f32 v82, v81, v115
    v_fmac_f32 v83, v81, v114
    v_cvt_pk_bf16_f32 v224, v80, v82
    buffer_load_dwordx4 v167, s[40:43], s67 offen offset:0 lds
    v_cvt_pk_bf16_f32 v228, v81, v83
    v_mul_f32 v84, v82, v114
    v_mul_f32 v85, v82, v116
    v_fmac_f32 v84, v83, v115
    v_fmac_f32 v85, v83, v114
    v_mul_f32 v86, v84, v114
    v_mul_f32 v87, v84, v116
    buffer_load_dwordx4 v168, s[40:43], s67 offen offset:1024 lds
    v_fmac_f32 v86, v85, v115
    v_fmac_f32 v87, v85, v114
    v_cvt_pk_bf16_f32 v225, v84, v86
    v_cvt_pk_bf16_f32 v229, v85, v87
    v_mul_f32 v88, v86, v114
    v_mul_f32 v89, v86, v116
    v_fmac_f32 v88, v87, v115
    buffer_load_dwordx4 v169, s[40:43], s67 offen offset:2048 lds
    s_add_u32 s69, s69, 41088
    s_cmp_lt_u32 s68, 123264
    s_cselect_b32 s97, 0, 123264
    s_sub_u32 s68, s68, s97
    s_sub_u32 s69, s69, s97
    v_fmac_f32 v89, v87, v114
    v_mul_f32 v90, v88, v114
    v_mul_f32 v91, v88, v116
    v_fmac_f32 v90, v89, v115
    v_fmac_f32 v91, v89, v114
    v_cvt_pk_bf16_f32 v226, v88, v90
    v_cvt_pk_bf16_f32 v230, v89, v91
    v_mul_f32 v92, v90, v114
    v_mul_f32 v93, v90, v116
    v_fmac_f32 v92, v91, v115
    s_waitcnt vmcnt(10)
    s_barrier
    s_cmp_lg_u32 s52, 0
    s_cbranch_scc1 L_h5
    global_load_dword v39, v38, s[34:35] sc1
L_h5:
    s_and_b32 s48, s48, 7
    s_mov_b32 m0, s68
    s_lshl_b32 s65, s48, 7
    s_mul_i32 s67, s48, 176128
    v_fmac_f32 v93, v91, v114
    v_mul_f32 v94, v92, v114
    v_mul_f32 v95, v92, v116
    v_fmac_f32 v94, v93, v115
    v_fmac_f32 v95, v93, v114
    v_cvt_pk_bf16_f32 v227, v92, v94
    buffer_load_dwordx4 v160, s[36:39], s65 offen offset:0 lds
    v_cvt_pk_bf16_f32 v231, v93, v95
    v_mul_f32 v82, v80, v120
    v_mul_f32 v83, v80, v122
    v_fmac_f32 v82, v81, v121
    v_fmac_f32 v83, v81, v120
    v_mul_f32 v86, v84, v120
    buffer_load_dwordx4 v161, s[36:39], s65 offen offset:1024 lds
    v_mul_f32 v87, v84, v122
    v_fmac_f32 v86, v85, v121
    v_fmac_f32 v87, v85, v120
    v_cvt_pk_bf16_f32 v232, v82, v86
    v_cvt_pk_bf16_f32 v236, v83, v87
    v_mul_f32 v90, v88, v120
    buffer_load_dwordx4 v162, s[36:39], s65 offen offset:2048 lds
    v_mul_f32 v91, v88, v122
    v_fmac_f32 v90, v89, v121
    v_fmac_f32 v91, v89, v120
    v_mul_f32 v94, v92, v120
    v_mul_f32 v95, v92, v122
    v_fmac_f32 v94, v93, v121
    buffer_load_dwordx4 v163, s[36:39], s65 offen offset:3072 lds
    s_mov_b32 m0, s69
    s_add_u32 s48, s48, 1
    v_fmac_f32 v95, v93, v120
    v_cvt_pk_bf16_f32 v233, v90, v94
    v_cvt_pk_bf16_f32 v237, v91, v95
    v_mul_f32 v80, v82, v120
    v_mul_f32 v81, v82, v122
    v_fmac_f32 v80, v83, v121
    buffer_load_dwordx4 v164, s[40:43], s67 offen offset:0 lds
    v_fmac_f32 v81, v83, v120
    v_mul_f32 v84, v90, v120
    v_mul_f32 v85, v90, v122
    v_fmac_f32 v84, v91, v121
    v_fmac_f32 v85, v91, v120
    v_cvt_pk_bf16_f32 v234, v80, v84
    buffer_load_dwordx4 v165, s[40:43], s67 offen offset:1024 lds
    v_cvt_pk_bf16_f32 v238, v81, v85
    v_mul_f32 v82, v80, v120
    v_mul_f32 v83, v80, v122
    v_fmac_f32 v82, v81, v121
    v_fmac_f32 v83, v81, v120
    v_mul_f32 v86, v84, v120
    buffer_load_dwordx4 v166, s[40:43], s67 offen offset:2048 lds
    s_add_u32 m0, s69, 3072
    s_add_u32 s68, s68, 41088
    v_mul_f32 v87, v84, v122
    v_fmac_f32 v86, v85, v121
    v_fmac_f32 v87, v85, v120
    v_cvt_pk_bf16_f32 v235, v82, v86
    v_cvt_pk_bf16_f32 v239, v83, v87
    v_mul_f32 v88, v82, v120
    buffer_load_dwordx4 v167, s[40:43], s67 offen offset:0 lds
    v_mul_f32 v89, v82, v122
    v_fmac_f32 v88, v83, v121
    v_fmac_f32 v89, v83, v120
    v_mul_f32 v90, v88, v120
    v_mul_f32 v91, v88, v122
    v_fmac_f32 v90, v89, v121
    buffer_load_dwordx4 v168, s[40:43], s67 offen offset:1024 lds
    v_fmac_f32 v91, v89, v120
    v_cvt_pk_bf16_f32 v240, v88, v90
    v_cvt_pk_bf16_f32 v244, v89, v91
    v_mul_f32 v88, v90, v120
    v_mul_f32 v89, v90, v122
    v_fmac_f32 v88, v91, v121
    buffer_load_dwordx4 v169, s[40:43], s67 offen offset:2048 lds
    s_add_u32 s69, s69, 41088
    s_cmp_lt_u32 s68, 123264
    s_cselect_b32 s97, 0, 123264
    s_sub_u32 s68, s68, s97
    s_sub_u32 s69, s69, s97
    v_fmac_f32 v89, v91, v120
    v_mul_f32 v90, v88, v120
    v_mul_f32 v91, v88, v122
    v_fmac_f32 v90, v89, v121
    v_fmac_f32 v91, v89, v120
    v_cvt_pk_bf16_f32 v241, v88, v90
    v_cvt_pk_bf16_f32 v245, v89, v91
    v_mul_f32 v88, v90, v120
    v_mul_f32 v89, v90, v122
    v_fmac_f32 v88, v91, v121
    v_fmac_f32 v89, v91, v120
    v_cvt_pk_bf16_f32 v242, v88, v88
    v_cvt_pk_bf16_f32 v246, v89, v89
    v_mul_f32 v47, v45, v47
    s_waitcnt vmcnt(10)
    v_cmp_gt_u32 vcc, 1, v39
    s_nop 1
    s_cbranch_vccz L_h6
    s_mov_b32 s61, 0x20000
L_p1:
    global_load_dword v39, v38, s[34:35] sc1
    s_sub_u32 s61, s61, 1
    s_waitcnt vmcnt(0)
    v_cmp_gt_u32 vcc, 1, v39
    s_cbranch_scc1 L_p1d
    s_nop 0
    s_cbranch_vccz L_p1d
    s_sleep 1
    s_branch L_p1
L_p1d:
L_h6:
    s_barrier
    global_load_dwordx4 v[164:167], v191, s[4:5]
    global_load_dword v62, v50, s[34:35] sc1
    global_load_dwordx4 v[116:119], v48, s[34:35] sc1
    global_load_dwordx4 v[120:123], v49, s[34:35] sc1
    s_mov_b32 s58, 0x01000100
    s_waitcnt vmcnt(4)
    s_waitcnt lgkmcnt(0)
    ds_write_b128 v58, v[192:195] offset:0
    s_waitcnt lgkmcnt(0)
    ds_write_b128 v58, v[196:199] offset:64
    s_waitcnt lgkmcnt(0)
    ds_write_b128 v58, v[200:203] offset:16
    s_waitcnt lgkmcnt(0)
    ds_write_b128 v58, v[204:207] offset:80
    s_waitcnt lgkmcnt(0)
    ds_write_b128 v58, v[208:211] offset:32
    s_barrier
    s_waitcnt vmcnt(2)
    v_and_b32 v70, 0xffff0000, v62
    v_rcp_f32 v71, v70
    v_perm_b32 v68, v62, v62, s58
    v_xor_b32 v68, 0x80008000, v68
    v_mov_b32 v69, v68
    v_mul_f32 v71, 0xbfb8aa3b, v71
    ds_write_b128 v61, v[68:71]
    ds_write_b32 v14, v28 offset:16
    s_waitcnt lgkmcnt(0)
    ds_write_b128 v58, v[212:215] offset:96
    s_waitcnt lgkmcnt(0)
    ds_write_b128 v58, v[216:219] offset:48
    s_waitcnt lgkmcnt(0)
    ds_write_b128 v58, v[220:223] offset:112
    s_waitcnt lgkmcnt(0)
    ds_read_b64_tr_b16 v[192:193], v59 offset:0
    ds_read_b64_tr_b16 v[194:195], v59 offset:64
    ds_read_b64_tr_b16 v[196:197], v59 offset:1152
    ds_read_b64_tr_b16 v[198:199], v59 offset:1216
    ds_read_b64_tr_b16 v[200:201], v59 offset:2304
    ds_read_b64_tr_b16 v[202:203], v59 offset:2368
    ds_read_b64_tr_b16 v[204:205], v59 offset:3456
    ds_read_b64_tr_b16 v[206:207], v59 offset:3520
    ds_read_b64_tr_b16 v[208:209], v59 offset:4608
    ds_read_b64_tr_b16 v[210:211], v59 offset:4672
    ds_read_b64_tr_b16 v[212:213], v59 offset:5760
    ds_read_b64_tr_b16 v[214:215], v59 offset:5824
    s_waitcnt lgkmcnt(8)
    ds_read_b64_tr_b16 v[216:217], v59 offset:6912
    ds_read_b64_tr_b16 v[218:219], v59 offset:6976
    ds_read_b64_tr_b16 v[220:221], v59 offset:8064
    ds_read_b64_tr_b16 v[222:223], v59 offset:8128
    s_waitcnt lgkmcnt(0)
    ds_write_b128 v58, v[224:227] offset:0
    s_waitcnt lgkmcnt(0)
    ds_write_b128 v58, v[228:231] offset:64
    s_waitcnt lgkmcnt(0)
    ds_write_b128 v58, v[232:235] offset:16
    s_waitcnt lgkmcnt(0)
    ds_write_b128 v58, v[236:239] offset:80
    s_waitcnt lgkmcnt(0)
    ds_write_b128 v58, v[240:243] offset:32
    s_waitcnt lgkmcnt(0)
    ds_write_b128 v58, v[244:247] offset:96
    s_waitcnt lgkmcnt(0)
    ds_read_b64_tr_b16 v[224:225], v59 offset:0
    ds_read_b64_tr_b16 v[226:227], v59 offset:64
    ds_read_b64_tr_b16 v[228:229], v59 offset:1152
    ds_read_b64_tr_b16 v[230:231], v59 offset:1216
    ds_read_b64_tr_b16 v[232:233], v59 offset:2304
    ds_read_b64_tr_b16 v[234:235], v59 offset:2368
    ds_read_b64_tr_b16 v[236:237], v59 offset:3456
    ds_read_b64_tr_b16 v[238:239], v59 offset:3520
    ds_read_b64_tr_b16 v[240:241], v59 offset:4608
    ds_read_b64_tr_b16 v[242:243], v59 offset:4672
    ds_read_b64_tr_b16 v[244:245], v59 offset:5760
    ds_read_b64_tr_b16 v[246:247], v59 offset:5824
    s_waitcnt lgkmcnt(8)
    ds_read_b64_tr_b16 v[248:249], v59 offset:6912
    ds_read_b64_tr_b16 v[250:251], v59 offset:6976
    ds_read_b64_tr_b16 v[252:253], v59 offset:8064
    ds_read_b64_tr_b16 v[254:255], v59 offset:8128
    s_setprio 3
    s_waitcnt lgkmcnt(12)
    v_mfma_f32_32x32x16_bf16 v[64:79], v[224:227], v[192:195], 0
    s_waitcnt lgkmcnt(12)
    v_mfma_f32_32x32x16_bf16 v[64:79], v[228:231], v[196:199], v[64:79]
    s_waitcnt lgkmcnt(10)
    v_mfma_f32_32x32x16_bf16 v[64:79], v[232:235], v[200:203], v[64:79]
    s_waitcnt lgkmcnt(8)
    v_mfma_f32_32x32x16_bf16 v[64:79], v[236:239], v[204:207], v[64:79]
    s_waitcnt lgkmcnt(6)
    v_mfma_f32_32x32x16_bf16 v[64:79], v[240:243], v[208:211], v[64:79]
    s_waitcnt lgkmcnt(4)
    v_mfma_f32_32x32x16_bf16 v[64:79], v[244:247], v[212:215], v[64:79]
    s_waitcnt lgkmcnt(2)
    v_mfma_f32_32x32x16_bf16 v[64:79], v[248:251], v[216:219], v[64:79]
    s_waitcnt lgkmcnt(0)
    v_mfma_f32_32x32x16_bf16 v[64:79], v[252:255], v[220:223], v[64:79]
    s_setprio 3
    s_waitcnt vmcnt(0)
    ds_write_b128 v60, v[116:119]
    ds_write_b128 v60, v[120:123] offset:512
    s_nop 2
    s_cmp_eq_u32 s63, 0
    s_nop 6
    s_cbranch_scc1 L_t0
    ds_write_b128 v12, v[64:67] offset:4608
    ds_write_b128 v12, v[68:71] offset:5632
    ds_write_b128 v12, v[72:75] offset:6656
    ds_write_b32 v13, v28 offset:48
    ds_write_b64 v63, v[26:27] offset:8448
    s_branch L_t1
L_t0:
    ds_write_b64 v15, v[26:27]
    ds_write_b64 v15, v[26:27] offset:4160
    s_mov_b32 s61, 0x100000
L_w2:
    ds_read_b32 v8, v13 offset:48
    ds_read_b128 v[80:83], v12 offset:4608
    ds_read_b128 v[84:87], v12 offset:5632
    ds_read_b128 v[88:91], v12 offset:6656
    s_sub_u32 s61, s61, 1
    s_waitcnt lgkmcnt(0)
    v_readfirstlane_b32 s60, v8
    s_cbranch_scc1 L_w2d
    s_cmp_lt_u32 s60, 1
    s_cbranch_scc1 L_w2
L_w2d:
    v_add_f32 v80, v80, v47
    v_add_f32 v80, v80, v64
    v_add_f32 v81, v81, v65
    v_add_f32 v82, v82, v66
    v_add_f32 v83, v83, v67
    v_add_f32 v84, v84, v68
    v_add_f32 v85, v85, v69
    v_add_f32 v86, v86, v70
    v_add_f32 v87, v87, v71
    v_add_f32 v88, v88, v72
    v_add_f32 v89, v89, v73
    v_add_f32 v90, v90, v74
    v_add_f32 v91, v91, v75
    v_cvt_pk_bf16_f32 v80, v80, v81
    v_cvt_pk_bf16_f32 v81, v82, v83
    v_cvt_pk_bf16_f32 v82, v84, v85
    v_cvt_pk_bf16_f32 v83, v86, v87
    v_cvt_pk_bf16_f32 v84, v88, v89
    v_cvt_pk_bf16_f32 v85, v90, v91
    ds_write_b64 v187, v[80:81]
    ds_write_b32 v188, v82 offset:512
    ds_write_b32 v189, v83 offset:516
    ds_write_b16 v190, v84 offset:1024
    ds_write_b16_d16_hi v190, v84 offset:1088
    ds_write_b16 v190, v85 offset:1152
    ds_write_b16_d16_hi v190, v85 offset:1216
    ds_write_b32 v13, v29 offset:48
    s_mov_b64 exec, 1
    ds_write_b16 v15, v80 offset:4190
    s_mov_b64 exec, -1
L_t1:
    s_mov_b32 s61, 0x100000
L_w3:
    ds_read_b32 v8, v13 offset:48
    s_sub_u32 s61, s61, 1
    s_waitcnt lgkmcnt(0)
    v_readfirstlane_b32 s60, v8
    s_cbranch_scc1 L_w3d
    s_cmp_lt_u32 s60, 2
    s_cbranch_scc1 L_w3
L_w3d:
    ds_read_u16 v170, v170
    ds_read_u16_d16_hi v171, v171
    ds_read_u16 v172, v172
    ds_read_u16_d16_hi v173, v173
    ds_read_u16 v174, v174
    ds_read_u16_d16_hi v175, v175
    ds_read_u16 v176, v176
    ds_read_u16_d16_hi v177, v177
    ds_read_u16 v178, v178
    ds_read_u16_d16_hi v179, v179
    ds_read_u16 v180, v180
    ds_read_u16_d16_hi v181, v181
    ds_read_u16 v182, v182
    ds_read_u16_d16_hi v183, v183
    s_waitcnt lgkmcnt(8)
    ds_read_u16 v184, v184
    ds_read_u16_d16_hi v185, v185
    ds_read_u16 v186, v186
    s_waitcnt lgkmcnt(10)
    v_or_b32 v100, v170, v171
    v_alignbit_b32 v108, v172, v171, 16
    v_or_b32 v101, v172, v173
    v_alignbit_b32 v109, v174, v173, 16
    v_or_b32 v102, v174, v175
    v_alignbit_b32 v110, v176, v175, 16
    s_waitcnt lgkmcnt(0)
    v_or_b32 v103, v176, v177
    v_alignbit_b32 v111, v178, v177, 16
    v_or_b32 v104, v178, v179
    v_alignbit_b32 v112, v180, v179, 16
    v_or_b32 v105, v180, v181
    v_alignbit_b32 v113, v182, v181, 16
    v_or_b32 v106, v182, v183
    v_alignbit_b32 v114, v184, v183, 16
    v_or_b32 v107, v184, v185
    v_alignbit_b32 v115, v186, v185, 16
    ds_write_b128 v37, v[100:103] offset:32
    ds_write_b128 v37, v[104:107] offset:48
    ds_write_b128 v37, v[108:111] offset:4192
    ds_write_b128 v37, v[112:115] offset:4208
    s_waitcnt lgkmcnt(0)
    s_barrier
    s_setprio 3
    ds_read_b128 v[124:127], v44 offset:3584
    ds_read_b128 v[120:123], v44 offset:3072
    ds_read2_b32 v[64:65], v40 offset0:0 offset1:1
    ds_read2_b32 v[66:67], v40 offset0:2 offset1:3
    ds_read_b128 v[116:119], v44 offset:2560
    ds_read2_b32 v[68:69], v40 offset0:128 offset1:129
    ds_read2_b32 v[70:71], v40 offset0:130 offset1:131
    ds_read_b128 v[112:115], v44 offset:2048
    ds_read2_b32 v[72:73], v41 offset0:0 offset1:1
    ds_read2_b32 v[74:75], v41 offset0:2 offset1:3
    ds_read_b128 v[108:111], v44 offset:1536
    ds_read2_b32 v[76:77], v41 offset0:128 offset1:129
    s_waitcnt lgkmcnt(8)
    ds_read2_b32 v[78:79], v41 offset0:130 offset1:131
    ds_read_b128 v[104:107], v44 offset:1024
    ds_read_b128 v[100:103], v44 offset:512
    ds_read_b128 v[96:99], v44 offset:0
    s_mov_b32 s66, 0
L_cv:
    s_waitcnt lgkmcnt(12)
    v_mfma_f32_16x16x32_bf16 v[156:159], v[64:67], v[124:127], v[156:159]
    v_subrev_u32 v44, 64, v44
    ds_read_b128 v[124:127], v44 offset:3584
    v_mfma_f32_16x16x32_bf16 v[152:155], v[64:67], v[120:123], v[152:155]
    ds_read2_b32 v[80:81], v42 offset0:0 offset1:1
    s_waitcnt lgkmcnt(13)
    v_mfma_f32_16x16x32_bf16 v[148:151], v[64:67], v[116:119], v[148:151]
    ds_read2_b32 v[82:83], v42 offset0:2 offset1:3
    s_waitcnt lgkmcnt(11)
    v_mfma_f32_16x16x32_bf16 v[144:147], v[64:67], v[112:115], v[144:147]
    ds_read2_b32 v[84:85], v42 offset0:128 offset1:129
    v_add_u32 v40, 64, v40
    s_waitcnt lgkmcnt(9)
    v_mfma_f32_16x16x32_bf16 v[140:143], v[64:67], v[108:111], v[140:143]
    ds_read2_b32 v[86:87], v42 offset0:130 offset1:131
    s_waitcnt lgkmcnt(7)
    v_mfma_f32_16x16x32_bf16 v[136:139], v[64:67], v[104:107], v[136:139]
    ds_read2_b32 v[88:89], v43 offset0:0 offset1:1
    v_add_u32 v41, 64, v41
    s_waitcnt lgkmcnt(7)
    v_mfma_f32_16x16x32_bf16 v[132:135], v[64:67], v[100:103], v[132:135]
    ds_read2_b32 v[90:91], v43 offset0:2 offset1:3
    s_waitcnt lgkmcnt(7)
    v_mfma_f32_16x16x32_bf16 v[128:131], v[64:67], v[96:99], v[128:131]
    ds_read2_b32 v[92:93], v43 offset0:128 offset1:129
    v_mfma_f32_16x16x32_bf16 v[156:159], v[68:71], v[120:123], v[156:159]
    ds_read2_b32 v[94:95], v43 offset0:130 offset1:131
    ds_read_b128 v[120:123], v44 offset:3072
    v_mfma_f32_16x16x32_bf16 v[152:155], v[68:71], v[116:119], v[152:155]
    ds_read2_b32 v[64:65], v40 offset0:0 offset1:1
    v_mfma_f32_16x16x32_bf16 v[148:151], v[68:71], v[112:115], v[148:151]
    ds_read2_b32 v[66:67], v40 offset0:2 offset1:3
    v_mfma_f32_16x16x32_bf16 v[144:147], v[68:71], v[108:111], v[144:147]
    v_mfma_f32_16x16x32_bf16 v[140:143], v[68:71], v[104:107], v[140:143]
    v_add_u32 v42, 64, v42
    v_mfma_f32_16x16x32_bf16 v[136:139], v[68:71], v[100:103], v[136:139]
    v_add_u32 v43, 64, v43
    v_mfma_f32_16x16x32_bf16 v[132:135], v[68:71], v[96:99], v[132:135]
    v_mfma_f32_16x16x32_bf16 v[156:159], v[72:75], v[116:119], v[156:159]
    ds_read_b128 v[116:119], v44 offset:2560
    v_mfma_f32_16x16x32_bf16 v[152:155], v[72:75], v[112:115], v[152:155]
    ds_read2_b32 v[68:69], v40 offset0:128 offset1:129
    v_mfma_f32_16x16x32_bf16 v[148:151], v[72:75], v[108:111], v[148:151]
    ds_read2_b32 v[70:71], v40 offset0:130 offset1:131
    v_mfma_f32_16x16x32_bf16 v[144:147], v[72:75], v[104:107], v[144:147]
    v_mfma_f32_16x16x32_bf16 v[140:143], v[72:75], v[100:103], v[140:143]
    v_mfma_f32_16x16x32_bf16 v[136:139], v[72:75], v[96:99], v[136:139]
    v_mfma_f32_16x16x32_bf16 v[156:159], v[76:79], v[112:115], v[156:159]
    ds_read_b128 v[112:115], v44 offset:2048
    v_mfma_f32_16x16x32_bf16 v[152:155], v[76:79], v[108:111], v[152:155]
    ds_read2_b32 v[72:73], v41 offset0:0 offset1:1
    v_mfma_f32_16x16x32_bf16 v[148:151], v[76:79], v[104:107], v[148:151]
    ds_read2_b32 v[74:75], v41 offset0:2 offset1:3
    v_mfma_f32_16x16x32_bf16 v[144:147], v[76:79], v[100:103], v[144:147]
    v_mfma_f32_16x16x32_bf16 v[140:143], v[76:79], v[96:99], v[140:143]
    s_waitcnt lgkmcnt(14)
    v_mfma_f32_16x16x32_bf16 v[156:159], v[80:83], v[108:111], v[156:159]
    ds_read_b128 v[108:111], v44 offset:1536
    v_mfma_f32_16x16x32_bf16 v[152:155], v[80:83], v[104:107], v[152:155]
    ds_read2_b32 v[76:77], v41 offset0:128 offset1:129
    v_mfma_f32_16x16x32_bf16 v[148:151], v[80:83], v[100:103], v[148:151]
    ds_read2_b32 v[78:79], v41 offset0:130 offset1:131
    v_mfma_f32_16x16x32_bf16 v[144:147], v[80:83], v[96:99], v[144:147]
    s_waitcnt lgkmcnt(14)
    v_mfma_f32_16x16x32_bf16 v[156:159], v[84:87], v[104:107], v[156:159]
    ds_read_b128 v[104:107], v44 offset:1024
    v_mfma_f32_16x16x32_bf16 v[152:155], v[84:87], v[100:103], v[152:155]
    s_cmp_lg_u32 s66, 0
    s_cbranch_scc1 L_cvb
    s_barrier
L_cvb:
    v_mfma_f32_16x16x32_bf16 v[148:151], v[84:87], v[96:99], v[148:151]
    v_mfma_f32_16x16x32_bf16 v[156:159], v[88:91], v[100:103], v[156:159]
    ds_read_b128 v[100:103], v44 offset:512
    s_add_u32 s66, s66, 1
    s_cmp_lt_u32 s66, 4
    v_mfma_f32_16x16x32_bf16 v[152:155], v[88:91], v[96:99], v[152:155]
    s_waitcnt lgkmcnt(14)
    v_mfma_f32_16x16x32_bf16 v[156:159], v[92:95], v[96:99], v[156:159]
    ds_read_b128 v[96:99], v44 offset:0
    s_cbranch_scc1 L_cv
    s_cmp_eq_u32 s63, 0
    s_waitcnt lgkmcnt(0)
    s_cbranch_scc1 L_x0
    ds_write_b128 v16, v[128:131] offset:0
    ds_write_b128 v16, v[132:135] offset:1024
    ds_write_b128 v16, v[136:139] offset:2048
    ds_write_b128 v16, v[140:143] offset:3072
    s_mov_b64 exec, 1
    ds_add_u32 v13, v28 offset:40
    s_mov_b64 exec, -1
    s_mov_b32 s61, 0x100000
L_w4:
    ds_read_b32 v8, v13 offset:40
    ds_read_b128 v[80:83], v17 offset:0
    ds_read_b128 v[84:87], v17 offset:1024
    ds_read_b128 v[88:91], v17 offset:2048
    ds_read_b128 v[92:95], v17 offset:3072
    s_sub_u32 s61, s61, 1
    s_waitcnt lgkmcnt(0)
    v_readfirstlane_b32 s60, v8
    s_cbranch_scc1 L_w4d
    s_cmp_lt_u32 s60, 2
    s_cbranch_scc1 L_w4
L_w4d:
    v_add_f32 v80, v80, v144
    v_add_f32 v81, v81, v145
    v_add_f32 v82, v82, v146
    v_add_f32 v83, v83, v147
    v_add_f32 v84, v84, v148
    v_add_f32 v85, v85, v149
    v_add_f32 v86, v86, v150
    v_add_f32 v87, v87, v151
    v_add_f32 v88, v88, v152
    v_add_f32 v89, v89, v153
    v_add_f32 v90, v90, v154
    v_add_f32 v91, v91, v155
    v_add_f32 v92, v92, v156
    v_add_f32 v93, v93, v157
    v_add_f32 v94, v94, v158
    v_add_f32 v95, v95, v159
    s_branch L_x1
L_x0:
    ds_write_b128 v16, v[144:147] offset:0
    ds_write_b128 v16, v[148:151] offset:1024
    ds_write_b128 v16, v[152:155] offset:2048
    ds_write_b128 v16, v[156:159] offset:3072
    s_mov_b64 exec, 1
    ds_add_u32 v13, v28 offset:40
    s_mov_b64 exec, -1
    s_mov_b32 s61, 0x100000
L_w5:
    ds_read_b32 v8, v13 offset:40
    ds_read_b128 v[80:83], v17 offset:0
    ds_read_b128 v[84:87], v17 offset:1024
    ds_read_b128 v[88:91], v17 offset:2048
    ds_read_b128 v[92:95], v17 offset:3072
    s_sub_u32 s61, s61, 1
    s_waitcnt lgkmcnt(0)
    v_readfirstlane_b32 s60, v8
    s_cbranch_scc1 L_w5d
    s_cmp_lt_u32 s60, 2
    s_cbranch_scc1 L_w5
L_w5d:
    v_add_f32 v80, v80, v128
    v_add_f32 v81, v81, v129
    v_add_f32 v82, v82, v130
    v_add_f32 v83, v83, v131
    v_add_f32 v84, v84, v132
    v_add_f32 v85, v85, v133
    v_add_f32 v86, v86, v134
    v_add_f32 v87, v87, v135
    v_add_f32 v88, v88, v136
    v_add_f32 v89, v89, v137
    v_add_f32 v90, v90, v138
    v_add_f32 v91, v91, v139
    v_add_f32 v92, v92, v140
    v_add_f32 v93, v93, v141
    v_add_f32 v94, v94, v142
    v_add_f32 v95, v95, v143
L_x1:
    v_cvt_pk_bf16_f32 v96, v80, v81
    v_cvt_pk_bf16_f32 v97, v82, v83
    ds_write_b64 v22, v[96:97] offset:0
    v_cvt_pk_bf16_f32 v98, v84, v85
    v_cvt_pk_bf16_f32 v99, v86, v87
    ds_write_b64 v22, v[98:99] offset:512
    v_cvt_pk_bf16_f32 v100, v88, v89
    v_cvt_pk_bf16_f32 v101, v90, v91
    ds_write_b64 v22, v[100:101] offset:1024
    v_cvt_pk_bf16_f32 v102, v92, v93
    v_cvt_pk_bf16_f32 v103, v94, v95
    ds_write_b64 v22, v[102:103] offset:1536
    ds_read_b128 v[104:107], v17
    ds_read_b128 v[108:111], v17 offset:1024
    s_waitcnt lgkmcnt(1)
    global_store_dwordx4 v21, v[104:107], s[34:35] sc1
    s_waitcnt lgkmcnt(0)
    global_store_dwordx4 v21, v[108:111], s[34:35] offset:1024 sc1
    ds_write_b32 v14, v29 offset:16
    v_lshlrev_b32 v60, 16, v164
    v_and_b32 v61, 0xffff0000, v164
    v_lshlrev_b32 v62, 16, v165
    v_and_b32 v63, 0xffff0000, v165
    v_lshlrev_b32 v64, 16, v166
    v_and_b32 v65, 0xffff0000, v166
    v_lshlrev_b32 v66, 16, v167
    v_and_b32 v67, 0xffff0000, v167
    v_mov_b32 v68, v191
    v_and_b32 v72, 15, v1
    v_lshrrev_b32 v73, 4, v1
    s_lshr_b32 s59, s52, 2
    s_and_b32 s58, s52, 1
    s_lshl1_add_u32 s58, s59, s58
    s_bfe_u32 s59, s52, 0x10001
    s_lshl_b32 s60, s59, 3
    v_lshl_add_u32 v69, v73, 1, s60
    v_xor_b32 v69, v69, v72
    s_and_b32 s60, s52, 1
    s_lshl_b32 s60, s60, 12
    s_cmp_lt_u32 s52, 4
    s_cselect_b32 s61, 22528, 0
    s_add_u32 s60, s60, s61
    v_lshl_add_u32 v72, v72, 8, s60
    v_lshl_add_u32 v69, v69, 4, v72
    v_xor_b32 v70, 16, v69
    v_add_u32 v74, 61440, v69
    v_add_u32 v75, 61440, v70
    v_bfe_u32 v71, v1, 2, 2
    v_lshl_add_u32 v71, v73, 3, v71
    v_mul_u32_u24 v71, 144, v71
    v_and_b32 v72, 3, v1
    v_lshl_add_u32 v71, v72, 3, v71
    s_mul_i32 s60, s59, 14592
    s_lshl_b32 s61, s58, 5
    s_add_u32 s60, s60, s61
    s_add_u32 s60, s60, 123264
    v_add_u32 v71, s60, v71
    s_waitcnt vmcnt(0)
    s_mov_b64 exec, 1
    v_mov_b32 v8, 1
    ds_add_rtn_u32 v9, v3, v8 offset:36
    s_waitcnt lgkmcnt(0)
    v_readfirstlane_b32 s60, v9
    s_mov_b64 exec, -1
    s_cmp_lg_u32 s60, 3
    s_cbranch_scc1 L_s3
    s_mov_b32 exec_hi, 0
    global_atomic_add v24, v28, s[34:35] sc1
    s_mov_b64 exec, -1
L_s3:
    s_setprio 0
    s_mov_b32 s61, 0x100000
L_w6:
    ds_read_b128 v[8:11], v3 offset:0
    s_sleep 1
    s_sub_u32 s61, s61, 1
    s_waitcnt lgkmcnt(0)
    v_min3_u32 v8, v8, v9, v10
    v_min_u32 v8, v8, v11
    s_nop 0
    v_readfirstlane_b32 s60, v8
    s_cbranch_scc1 L_w6d
    s_cmp_lt_u32 s60, 10
    s_cbranch_scc1 L_w6
L_w6d:
    s_setprio 0
    global_load_dword v25, v23, s[34:35] sc1
    ds_read_b128 v[80:83], v69 offset:0
    ds_read_b128 v[84:87], v70 offset:0
    ds_read_b128 v[88:91], v69 offset:30720
    ds_read_b128 v[92:95], v70 offset:30720
    ds_read_b128 v[96:99], v74 offset:0
    ds_read_b128 v[100:103], v75 offset:0
    ds_read_b128 v[104:107], v74 offset:30720
    ds_read_b128 v[108:111], v75 offset:30720
    v_mov_b32 v116, 0xbfb8aa3b
    v_mov_b32 v117, 1.0
    s_waitcnt lgkmcnt(4)
    v_add_f32 v80, v80, v88
    v_add_f32 v81, v81, v89
    v_add_f32 v82, v82, v90
    v_add_f32 v83, v83, v91
    v_add_f32 v84, v84, v92
    v_add_f32 v85, v85, v93
    v_add_f32 v86, v86, v94
    v_add_f32 v87, v87, v95
    s_waitcnt lgkmcnt(0)
    v_add_f32 v96, v96, v104
    v_add_f32 v97, v97, v105
    v_add_f32 v98, v98, v106
    v_add_f32 v99, v99, v107
    v_add_f32 v100, v100, v108
    v_add_f32 v101, v101, v109
    v_add_f32 v102, v102, v110
    v_add_f32 v103, v103, v111
    v_add_f32 v80, v80, v96
    v_add_f32 v81, v81, v97
    v_add_f32 v82, v82, v98
    v_add_f32 v83, v83, v99
    v_add_f32 v84, v84, v100
    v_add_f32 v85, v85, v101
    v_add_f32 v86, v86, v102
    v_add_f32 v87, v87, v103
    v_mul_f32 v88, v116, v80
    v_mul_f32 v89, v116, v81
    v_mul_f32 v90, v116, v82
    v_mul_f32 v91, v116, v83
    v_mul_f32 v92, v116, v84
    v_mul_f32 v93, v116, v85
    v_mul_f32 v94, v116, v86
    v_mul_f32 v95, v116, v87
    v_exp_f32 v88, v88
    v_exp_f32 v89, v89
    v_exp_f32 v90, v90
    v_exp_f32 v91, v91
    v_exp_f32 v92, v92
    v_exp_f32 v93, v93
    v_exp_f32 v94, v94
    v_exp_f32 v95, v95
    v_add_f32 v88, 1.0, v88
    v_add_f32 v89, 1.0, v89
    v_add_f32 v90, 1.0, v90
    v_add_f32 v91, 1.0, v91
    v_add_f32 v92, 1.0, v92
    v_add_f32 v93, 1.0, v93
    v_add_f32 v94, 1.0, v94
    v_add_f32 v95, 1.0, v95
    v_rcp_f32 v88, v88
    v_rcp_f32 v89, v89
    v_rcp_f32 v90, v90
    v_rcp_f32 v91, v91
    v_rcp_f32 v92, v92
    v_rcp_f32 v93, v93
    v_rcp_f32 v94, v94
    v_rcp_f32 v95, v95
    s_setprio 3
    s_waitcnt vmcnt(0)
    v_cmp_gt_u32 vcc, 32, v25
    s_nop 1
    s_cbranch_vccz L_s4
    s_mov_b32 s61, 0x20000
L_p7:
    global_load_dword v25, v23, s[34:35] sc1
    s_sub_u32 s61, s61, 1
    s_waitcnt vmcnt(0)
    v_cmp_gt_u32 vcc, 32, v25
    s_cbranch_scc1 L_p7d
    s_nop 0
    s_cbranch_vccz L_p7d
    s_sleep 1
    s_branch L_p7
L_p7d:
L_s4:
    global_load_dwordx4 v[24:27], v18, s[34:35] sc1
    global_load_dwordx4 v[28:31], v19, s[34:35] sc1
    s_waitcnt vmcnt(1)
    ds_write_b128 v20, v[24:27]
    s_waitcnt vmcnt(0)
    ds_write_b128 v20, v[28:31] offset:1152
L_xnc:
    s_waitcnt lgkmcnt(0)
    s_barrier
    ds_read_b64_tr_b16 v[112:113], v71
    ds_read_b64_tr_b16 v[114:115], v71 offset:576
    s_branch L_fin
L_gemm:
    s_setprio 2
    s_sub_u32 s62, s52, 4
    s_lshr_b32 s63, s62, 1
    s_and_b32 s64, s62, 1
    v_and_b32 v18, 31, v1
    v_lshrrev_b32 v19, 5, v1
    v_bfe_u32 v17, v1, 1, 3
    v_xor_b32 v19, v19, v17
    s_lshl_b32 s58, s63, 13
    v_lshl_add_u32 v16, v18, 7, s58
    v_lshl_add_u32 v16, v19, 4, v16
    s_lshl_b32 s58, s63, 6
    v_xor_b32 v4, s58, v16
    v_xor_b32 v5, 32, v4
    v_xor_b32 v6, 64, v4
    v_xor_b32 v7, 96, v4
    v_bfe_u32 v17, v1, 2, 2
    v_lshrrev_b32 v19, 5, v1
    v_lshl_add_u32 v17, v19, 3, v17
    v_mul_u32_u24 v16, 192, v17
    v_bfe_u32 v17, v1, 4, 1
    v_mul_u32_u24 v17, 12320, v17
    v_and_b32 v19, 3, v1
    v_lshl_add_u32 v17, v19, 3, v17
    s_mul_i32 s58, s64, 96
    s_add_u32 s58, s58, 16384
    s_mul_i32 s59, s63, 6144
    s_add_u32 s60, s58, s59
    v_add3_u32 v8, v16, v17, s60
    s_sub_u32 s60, s58, s59
    s_add_u32 s60, s60, 6144
    v_add3_u32 v9, v16, v17, s60
    v_lshl_add_u32 v10, s62, 2, v3
    v_cmp_eq_u32 vcc, 0, v18
    v_cmp_eq_u32 s[58:59], 20, v18
    v_mov_b32 v19, 0x3f803f80
    s_or_b64 vcc, vcc, s[58:59]
    s_mul_i32 s59, s62, 2176
    s_sub_u32 s59, 158976, s59
    v_cndmask_b32 v20, 0, v19, vcc
    v_lshl_add_u32 v218, v1, 4, s59
    v_lshl_add_u32 v219, s62, 3, v3
    v_mov_b32 v21, v20
    v_mov_b32 v22, v20
    v_mov_b32 v23, v20
    s_waitcnt vmcnt(0)
L_ln:
    v_dot2_f32_bf16 v208, v184, v19, 0
    v_dot2_f32_bf16 v209, v188, v19, 0
    v_dot2_f32_bf16 v210, v184, v184, 0
    v_dot2_f32_bf16 v211, v188, v188, 0
    v_dot2_f32_bf16 v208, v185, v19, v208
    v_dot2_f32_bf16 v209, v189, v19, v209
    v_dot2_f32_bf16 v210, v185, v185, v210
    v_dot2_f32_bf16 v211, v189, v189, v211
    v_dot2_f32_bf16 v208, v186, v19, v208
    v_dot2_f32_bf16 v209, v190, v19, v209
    v_dot2_f32_bf16 v210, v186, v186, v210
    v_dot2_f32_bf16 v211, v190, v190, v211
    v_dot2_f32_bf16 v208, v187, v19, v208
    v_dot2_f32_bf16 v209, v191, v19, v209
    v_dot2_f32_bf16 v210, v187, v187, v210
    v_dot2_f32_bf16 v211, v191, v191, v211
    v_lshlrev_b32 v192, 16, v184
    v_and_b32 v193, 0xffff0000, v184
    v_lshlrev_b32 v200, 16, v188
    v_and_b32 v201, 0xffff0000, v188
    v_lshlrev_b32 v194, 16, v185
    v_and_b32 v195, 0xffff0000, v185
    v_lshlrev_b32 v202, 16, v189
    v_and_b32 v203, 0xffff0000, v189
    v_lshlrev_b32 v196, 16, v186
    v_and_b32 v197, 0xffff0000, v186
    v_lshlrev_b32 v204, 16, v190
    v_and_b32 v205, 0xffff0000, v190
    v_lshlrev_b32 v198, 16, v187
    v_and_b32 v199, 0xffff0000, v187
    v_lshlrev_b32 v206, 16, v191
    v_and_b32 v207, 0xffff0000, v191
    v_add_f32_dpp v208, v208, v208 row_ror:8 row_mask:0xf bank_mask:0xf
    v_add_f32_dpp v209, v209, v209 row_ror:8 row_mask:0xf bank_mask:0xf
    v_add_f32_dpp v210, v210, v210 row_ror:8 row_mask:0xf bank_mask:0xf
    v_add_f32_dpp v211, v211, v211 row_ror:8 row_mask:0xf bank_mask:0xf
    v_add_f32_dpp v208, v208, v208 row_ror:4 row_mask:0xf bank_mask:0xf
    v_add_f32_dpp v209, v209, v209 row_ror:4 row_mask:0xf bank_mask:0xf
    v_add_f32_dpp v210, v210, v210 row_ror:4 row_mask:0xf bank_mask:0xf
    v_add_f32_dpp v211, v211, v211 row_ror:4 row_mask:0xf bank_mask:0xf
    v_add_f32_dpp v208, v208, v208 row_ror:2 row_mask:0xf bank_mask:0xf
    v_add_f32_dpp v209, v209, v209 row_ror:2 row_mask:0xf bank_mask:0xf
    v_add_f32_dpp v210, v210, v210 row_ror:2 row_mask:0xf bank_mask:0xf
    v_add_f32_dpp v211, v211, v211 row_ror:2 row_mask:0xf bank_mask:0xf
    v_add_f32_dpp v208, v208, v208 row_ror:1 row_mask:0xf bank_mask:0xf
    v_add_f32_dpp v209, v209, v209 row_ror:1 row_mask:0xf bank_mask:0xf
    v_add_f32_dpp v210, v210, v210 row_ror:1 row_mask:0xf bank_mask:0xf
    v_add_f32_dpp v211, v211, v211 row_ror:1 row_mask:0xf bank_mask:0xf
    v_add_f32_dpp v208, v208, v208 row_bcast:15 row_mask:0xa bank_mask:0xf
    v_add_f32_dpp v209, v209, v209 row_bcast:15 row_mask:0xa bank_mask:0xf
    v_add_f32_dpp v210, v210, v210 row_bcast:15 row_mask:0xa bank_mask:0xf
    v_add_f32_dpp v211, v211, v211 row_bcast:15 row_mask:0xa bank_mask:0xf
    v_add_f32_dpp v208, v208, v208 row_bcast:31 row_mask:0xc bank_mask:0xf
    v_add_f32_dpp v209, v209, v209 row_bcast:31 row_mask:0xc bank_mask:0xf
    v_add_f32_dpp v210, v210, v210 row_bcast:31 row_mask:0xc bank_mask:0xf
    v_add_f32_dpp v211, v211, v211 row_bcast:31 row_mask:0xc bank_mask:0xf
    v_mul_f32 v184, 0x3b000000, v208
    v_mul_f32 v185, 0x3b000000, v209
    v_mul_f32 v186, 0x3b000000, v210
    v_mul_f32 v187, 0x3b000000, v211
    v_fma_f32 v186, -v184, v184, v186
    v_fma_f32 v187, -v185, v185, v187
    v_max_f32 v186, 0, v186
    v_max_f32 v187, 0, v187
    v_cvt_pk_bf16_f32 v188, v186, v187
    v_cvt_pk_bf16_f32 v189, v184, v185
    v_lshlrev_b32 v186, 16, v188
    v_and_b32 v187, 0xffff0000, v188
    v_add_f32 v186, 0x3727c5ac, v186
    v_add_f32 v187, 0x3727c5ac, v187
    v_cvt_pk_bf16_f32 v188, v186, v187
    v_lshlrev_b32 v186, 16, v188
    v_and_b32 v187, 0xffff0000, v188
    v_sqrt_f32 v186, v186
    v_sqrt_f32 v187, v187
    v_lshlrev_b32 v184, 16, v189
    v_cvt_pk_bf16_f32 v188, v186, v187
    v_and_b32 v185, 0xffff0000, v189
    v_lshlrev_b32 v186, 16, v188
    v_and_b32 v187, 0xffff0000, v188
    v_and_b32 v190, 0xffff, v189
    v_or_b32 v216, v190, v186
    v_lshrrev_b32 v191, 16, v189
    v_or_b32 v217, v191, v187
    v_rcp_f32 v186, v186
    v_rcp_f32 v187, v187
    s_nop 0
    v_mul_f32 v184, v184, v186
    v_mul_f32 v185, v185, v187
    v_readlane_b32 s58, v186, 63
    v_readlane_b32 s59, v187, 63
    v_readlane_b32 s60, v184, 63
    v_readlane_b32 s61, v185, 63
    s_nop 1
    v_mov_b32 v184, s60
    v_mov_b32 v185, s61
    v_pk_fma_f32 v[192:193], v[192:193], s[58:59], v[184:185] op_sel:[0,0,0] op_sel_hi:[1,0,0] neg_lo:[0,0,1] neg_hi:[0,0,1]
    v_pk_fma_f32 v[200:201], v[200:201], s[58:59], v[184:185] op_sel:[0,1,1] op_sel_hi:[1,1,1] neg_lo:[0,0,1] neg_hi:[0,0,1]
    v_pk_fma_f32 v[194:195], v[194:195], s[58:59], v[184:185] op_sel:[0,0,0] op_sel_hi:[1,0,0] neg_lo:[0,0,1] neg_hi:[0,0,1]
    v_pk_fma_f32 v[202:203], v[202:203], s[58:59], v[184:185] op_sel:[0,1,1] op_sel_hi:[1,1,1] neg_lo:[0,0,1] neg_hi:[0,0,1]
    v_pk_fma_f32 v[196:197], v[196:197], s[58:59], v[184:185] op_sel:[0,0,0] op_sel_hi:[1,0,0] neg_lo:[0,0,1] neg_hi:[0,0,1]
    v_pk_fma_f32 v[204:205], v[204:205], s[58:59], v[184:185] op_sel:[0,1,1] op_sel_hi:[1,1,1] neg_lo:[0,0,1] neg_hi:[0,0,1]
    v_pk_fma_f32 v[198:199], v[198:199], s[58:59], v[184:185] op_sel:[0,0,0] op_sel_hi:[1,0,0] neg_lo:[0,0,1] neg_hi:[0,0,1]
    v_pk_fma_f32 v[206:207], v[206:207], s[58:59], v[184:185] op_sel:[0,1,1] op_sel_hi:[1,1,1] neg_lo:[0,0,1] neg_hi:[0,0,1]
    v_cvt_pk_bf16_f32 v208, v192, v193
    v_cvt_pk_bf16_f32 v212, v200, v201
    v_cvt_pk_bf16_f32 v209, v194, v195
    v_cvt_pk_bf16_f32 v213, v202, v203
    v_cvt_pk_bf16_f32 v210, v196, v197
    v_cvt_pk_bf16_f32 v214, v204, v205
    v_cvt_pk_bf16_f32 v211, v198, v199
    v_cvt_pk_bf16_f32 v215, v206, v207
    ds_write_b128 v218, v[208:211] offset:1088
    ds_write_b128 v218, v[212:215]
    s_mov_b32 exec_lo, 0
    s_brev_b32 exec_hi, 1
    ds_write_b64 v219, v[216:217] offset:64
    s_mov_b64 exec, -1
    s_waitcnt lgkmcnt(0)
    s_cmp_eq_u32 s54, 15
    s_barrier
    s_cbranch_scc1 L_idle
    ds_read_b64_tr_b16 v[44:45], v8 offset:0
    ds_read_b64_tr_b16 v[46:47], v8 offset:768
    ds_read_b128 v[36:39], v4
    ds_read_b128 v[40:43], v4 offset:4096
    ds_read_b64_tr_b16 v[48:49], v8 offset:32
    ds_read_b64_tr_b16 v[50:51], v8 offset:800
    ds_read_b64_tr_b16 v[52:53], v8 offset:64
    ds_read_b64_tr_b16 v[54:55], v8 offset:832
    s_lshr_b32 s59, s52, 2
    s_and_b32 s58, s52, 1
    s_lshl1_add_u32 s58, s59, s58
    s_lshl2_add_u32 s58, s55, s58
    s_lshl_b32 s58, s58, 14
    s_lshl_b32 s59, s56, 7
    s_add_u32 s58, s58, s59
    s_and_b32 s59, s52, 2
    s_lshl_b32 s59, s59, 5
    s_add_u32 s58, s58, s59
    v_and_b32 v11, 15, v1
    v_lshl_add_u32 v11, v11, 10, s58
    v_and_b32 v76, 48, v1
    v_add_u32 v11, v11, v76
    v_mov_b32 v222, 0
    v_mov_b32 v223, 0
    v_mov_b32 v226, 0
    v_mov_b32 v227, 0
    v_mov_b32 v230, 0
    v_mov_b32 v231, 0
    v_mov_b32 v234, 0
    v_mov_b32 v235, 0
    v_mov_b32 v238, 0
    v_mov_b32 v239, 0
    s_waitcnt lgkmcnt(0)
    v_mfma_f32_32x32x16_bf16 v[80:95], v[44:47], v[36:39], 0
    ds_read_b64_tr_b16 v[64:65], v8 offset:3072
    ds_read_b64_tr_b16 v[66:67], v8 offset:3840
    s_mul_i32 s58, s62, 768
    s_add_u32 s58, s58, 152448
    v_lshl_add_u32 v16, v1, 2, s58
    s_xor_b32 s59, s62, 2
    v_lshl_add_u32 v15, s59, 2, v3
    v_mfma_f32_32x32x16_bf16 v[128:143], v[44:47], v[40:43], 0
    ds_read_b128 v[56:59], v5
    ds_read_b128 v[60:63], v5 offset:4096
    s_mul_i32 s58, s59, 768
    s_add_u32 s58, s58, 152448
    v_lshl_add_u32 v17, v1, 2, s58
    s_lshl_b32 s58, s63, 10
    s_add_u32 s58, s58, 161664
    v_mfma_f32_16x16x32_bf16 v[24:27], v[20:23], v[44:47], 0
    v_mfma_f32_32x32x16_bf16 v[96:111], v[48:51], v[36:39], 0
    ds_read_b64_tr_b16 v[68:69], v8 offset:3104
    ds_read_b64_tr_b16 v[70:71], v8 offset:3872
    v_lshl_add_u32 v19, v18, 4, s58
    s_mov_b32 s44, s34
    s_mov_b32 s45, s35
    s_mov_b32 s46, 5636096
    s_mov_b32 s47, 0x20000
    v_mfma_f32_32x32x16_bf16 v[144:159], v[48:51], v[40:43], 0
    ds_read_b64_tr_b16 v[72:73], v8 offset:3136
    ds_read_b64_tr_b16 v[74:75], v8 offset:3904
    s_lshl_b32 s58, s54, 1
    s_add_u32 s58, s58, s64
    s_mul_i32 s58, s58, 196608
    s_lshl_b32 s59, s53, 1
    s_add_u32 s59, s59, s63
    v_mfma_f32_16x16x32_bf16 v[28:31], v[20:23], v[48:51], 0
    v_mfma_f32_32x32x16_bf16 v[112:127], v[52:55], v[36:39], 0
    s_lshl_b32 s59, s59, 11
    s_add_u32 s58, s58, s59
    v_lshl_add_u32 v2, v1, 4, s58
    v_mov_b32 v14, 9
    s_mul_i32 s40, s56, 0
    v_mfma_f32_32x32x16_bf16 v[160:175], v[52:55], v[40:43], 0
    s_mul_i32 s59, s55, 1
    s_add_u32 s40, s40, s59
    s_and_b32 s40, s40, 3
    s_cselect_b32 s59, 2, 0
    s_mul_i32 s40, s40, 5
    v_mfma_f32_16x16x32_bf16 v[32:35], v[20:23], v[52:55], 0
    s_waitcnt lgkmcnt(0)
    v_mfma_f32_32x32x16_bf16 v[80:95], v[64:67], v[56:59], v[80:95]
    ds_read_b64_tr_b16 v[44:45], v9 offset:0
    ds_read_b64_tr_b16 v[46:47], v9 offset:768
    s_add_u32 s40, s40, s59
    s_add_u32 s41, s40, 5
    s_cmp_eq_u32 s41, 22
    s_cselect_b32 s41, 0, s41
    s_add_u32 s42, s41, 5
    v_mfma_f32_32x32x16_bf16 v[128:143], v[64:67], v[60:63], v[128:143]
    ds_read_b128 v[36:39], v6
    ds_read_b128 v[40:43], v6 offset:4096
    s_cmp_eq_u32 s42, 22
    s_cselect_b32 s42, 0, s42
    s_add_u32 s43, s42, 5
    s_cmp_eq_u32 s43, 22
    s_cselect_b32 s43, 0, s43
    v_mfma_f32_16x16x32_bf16 v[24:27], v[20:23], v[64:67], v[24:27]
    v_mfma_f32_32x32x16_bf16 v[96:111], v[68:71], v[56:59], v[96:111]
    ds_read_b64_tr_b16 v[48:49], v9 offset:32
    ds_read_b64_tr_b16 v[50:51], v9 offset:800
    s_lshl_b32 s40, s40, 14
    s_lshl_b32 s41, s41, 14
    s_lshl_b32 s42, s42, 14
    s_lshl_b32 s43, s43, 14
    s_add_u32 s36, s34, 11534336
    v_mfma_f32_32x32x16_bf16 v[144:159], v[68:71], v[60:63], v[144:159]
    ds_read_b64_tr_b16 v[52:53], v9 offset:64
    ds_read_b64_tr_b16 v[54:55], v9 offset:832
    s_addc_u32 s37, s35, 0
    s_mov_b32 s38, 1441792
    s_mov_b32 s39, 0x20000
    s_mul_i32 s58, s62, 360448
    s_lshl_b32 s59, s56, 11
    v_mfma_f32_16x16x32_bf16 v[28:31], v[20:23], v[68:71], v[28:31]
    v_mfma_f32_32x32x16_bf16 v[112:127], v[72:75], v[56:59], v[112:127]
    s_add_u32 s58, s58, s59
    v_lshl_add_u32 v18, v1, 4, s58
    s_mul_i32 s68, s62, 30720
    s_lshl_b32 s58, s2, 7
    s_add_u32 s58, s58, 10616832
    v_mfma_f32_32x32x16_bf16 v[160:175], v[72:75], v[60:63], v[160:175]
    v_lshl_add_u32 v12, v1, 4, s58
    s_add_u32 s100, s100, 1
    s_add_u32 s101, s101, 1
    v_mov_b32 v240, s100
    v_mov_b32 v241, s101
    v_mfma_f32_16x16x32_bf16 v[32:35], v[20:23], v[72:75], v[32:35]
    s_waitcnt lgkmcnt(0)
    v_mfma_f32_32x32x16_bf16 v[80:95], v[44:47], v[36:39], v[80:95]
    ds_read_b64_tr_b16 v[64:65], v9 offset:3072
    ds_read_b64_tr_b16 v[66:67], v9 offset:3840
    v_mov_b32 v242, s100
    v_mov_b32 v243, s101
    v_mov_b32 v13, 1
    s_mov_b32 s49, 1
    s_mov_b32 s51, 41088
    v_mfma_f32_32x32x16_bf16 v[128:143], v[44:47], v[40:43], v[128:143]
    ds_read_b128 v[56:59], v7
    ds_read_b128 v[60:63], v7 offset:4096
    s_mov_b32 s50, 4294885120
    v_mfma_f32_32x32x16_bf16 v[96:111], v[48:51], v[36:39], v[96:111]
    ds_read_b64_tr_b16 v[68:69], v9 offset:3104
    ds_read_b64_tr_b16 v[70:71], v9 offset:3872
    v_mfma_f32_32x32x16_bf16 v[144:159], v[48:51], v[40:43], v[144:159]
    ds_read_b64_tr_b16 v[72:73], v9 offset:3136
    ds_read_b64_tr_b16 v[74:75], v9 offset:3904
    v_mfma_f32_32x32x16_bf16 v[112:127], v[52:55], v[36:39], v[112:127]
    v_add_u32 v4, 41088, v4
    v_add_u32 v5, 41088, v5
    v_add_u32 v6, 41088, v6
    v_add_u32 v7, 41088, v7
    v_add_u32 v8, 41088, v8
    v_add_u32 v9, 41088, v9
    v_mfma_f32_32x32x16_bf16 v[160:175], v[52:55], v[40:43], v[160:175]
    s_waitcnt lgkmcnt(0)
    s_branch L_g1
L_pub:
    global_load_dwordx4 v[76:79], v11, s[4:5]
    s_cmp_lg_u32 s62, 0
    s_cbranch_scc1 L_pubr
    s_mov_b64 exec, 0xff
    global_store_dwordx4 v12, v[240:243], s[34:35] sc1
    s_mov_b64 exec, -1
    s_branch L_pubr
L_g1:
    s_barrier
    v_mfma_f32_32x32x16_bf16 v[80:95], v[64:67], v[56:59], v[80:95]
    ds_read_b64_tr_b16 v[44:45], v8 offset:0
    ds_read_b64_tr_b16 v[46:47], v8 offset:768
    v_mfma_f32_32x32x16_bf16 v[128:143], v[64:67], v[60:63], v[128:143]
    ds_read_b128 v[36:39], v4
    ds_read_b128 v[40:43], v4 offset:4096
    v_mfma_f32_32x32x16_bf16 v[96:111], v[68:71], v[56:59], v[96:111]
    ds_read_b64_tr_b16 v[48:49], v8 offset:32
    ds_read_b64_tr_b16 v[50:51], v8 offset:800
    v_mfma_f32_32x32x16_bf16 v[144:159], v[68:71], v[60:63], v[144:159]
    ds_read_b64_tr_b16 v[52:53], v8 offset:64
    ds_read_b64_tr_b16 v[54:55], v8 offset:832
    v_mfma_f32_32x32x16_bf16 v[112:127], v[72:75], v[56:59], v[112:127]
    s_cmp_eq_u32 s49, 1
    s_cbranch_scc1 L_pub
L_pubr:
    v_mfma_f32_32x32x16_bf16 v[160:175], v[72:75], v[60:63], v[160:175]
    s_waitcnt lgkmcnt(0)
    v_mfma_f32_32x32x16_bf16 v[80:95], v[44:47], v[36:39], v[80:95]
    ds_read_b64_tr_b16 v[64:65], v8 offset:3072
    ds_read_b64_tr_b16 v[66:67], v8 offset:3840
    v_mfma_f32_32x32x16_bf16 v[128:143], v[44:47], v[40:43], v[128:143]
    ds_read_b128 v[56:59], v5
    ds_read_b128 v[60:63], v5 offset:4096
    v_mfma_f32_16x16x32_bf16 v[24:27], v[20:23], v[44:47], v[24:27]
    v_mfma_f32_32x32x16_bf16 v[96:111], v[48:51], v[36:39], v[96:111]
    ds_read_b64_tr_b16 v[68:69], v8 offset:3104
    ds_read_b64_tr_b16 v[70:71], v8 offset:3872
    v_mfma_f32_32x32x16_bf16 v[144:159], v[48:51], v[40:43], v[144:159]
    ds_read_b64_tr_b16 v[72:73], v8 offset:3136
    ds_read_b64_tr_b16 v[74:75], v8 offset:3904
    v_mfma_f32_16x16x32_bf16 v[28:31], v[20:23], v[48:51], v[28:31]
    v_mfma_f32_32x32x16_bf16 v[112:127], v[52:55], v[36:39], v[112:127]
    v_mfma_f32_32x32x16_bf16 v[160:175], v[52:55], v[40:43], v[160:175]
    v_mfma_f32_16x16x32_bf16 v[32:35], v[20:23], v[52:55], v[32:35]
    s_waitcnt lgkmcnt(0)
    v_mfma_f32_32x32x16_bf16 v[80:95], v[64:67], v[56:59], v[80:95]
    ds_read_b64_tr_b16 v[44:45], v9 offset:0
    ds_read_b64_tr_b16 v[46:47], v9 offset:768
    v_mfma_f32_32x32x16_bf16 v[128:143], v[64:67], v[60:63], v[128:143]
    ds_read_b128 v[36:39], v6
    ds_read_b128 v[40:43], v6 offset:4096
    v_mfma_f32_16x16x32_bf16 v[24:27], v[20:23], v[64:67], v[24:27]
    v_mfma_f32_32x32x16_bf16 v[96:111], v[68:71], v[56:59], v[96:111]
    ds_read_b64_tr_b16 v[48:49], v9 offset:32
    ds_read_b64_tr_b16 v[50:51], v9 offset:800
    v_mfma_f32_32x32x16_bf16 v[144:159], v[68:71], v[60:63], v[144:159]
    ds_read_b64_tr_b16 v[52:53], v9 offset:64
    ds_read_b64_tr_b16 v[54:55], v9 offset:832
    v_mfma_f32_16x16x32_bf16 v[28:31], v[20:23], v[68:71], v[28:31]
    v_mfma_f32_32x32x16_bf16 v[112:127], v[72:75], v[56:59], v[112:127]
    v_mfma_f32_32x32x16_bf16 v[160:175], v[72:75], v[60:63], v[160:175]
    v_mfma_f32_16x16x32_bf16 v[32:35], v[20:23], v[72:75], v[32:35]
    s_waitcnt lgkmcnt(0)
    v_mfma_f32_32x32x16_bf16 v[80:95], v[44:47], v[36:39], v[80:95]
    ds_read_b64_tr_b16 v[64:65], v9 offset:3072
    ds_read_b64_tr_b16 v[66:67], v9 offset:3840
    v_mfma_f32_32x32x16_bf16 v[128:143], v[44:47], v[40:43], v[128:143]
    ds_read_b128 v[56:59], v7
    ds_read_b128 v[60:63], v7 offset:4096
    v_mfma_f32_32x32x16_bf16 v[96:111], v[48:51], v[36:39], v[96:111]
    ds_read_b64_tr_b16 v[68:69], v9 offset:3104
    ds_read_b64_tr_b16 v[70:71], v9 offset:3872
    v_mfma_f32_32x32x16_bf16 v[144:159], v[48:51], v[40:43], v[144:159]
    ds_read_b64_tr_b16 v[72:73], v9 offset:3136
    ds_read_b64_tr_b16 v[74:75], v9 offset:3904
    s_cmp_eq_u32 s51, 82176
    s_cselect_b32 s48, s50, 41088
    v_mfma_f32_32x32x16_bf16 v[112:127], v[52:55], v[36:39], v[112:127]
    s_add_u32 s51, s51, s48
    v_add_u32 v4, s48, v4
    v_add_u32 v5, s48, v5
    v_add_u32 v6, s48, v6
    v_add_u32 v7, s48, v7
    v_add_u32 v8, s48, v8
    v_add_u32 v9, s48, v9
    v_mfma_f32_32x32x16_bf16 v[160:175], v[52:55], v[40:43], v[160:175]
    s_add_u32 s49, s49, 1
    s_cmp_lt_u32 s49, 7
    s_waitcnt lgkmcnt(0)
    s_cbranch_scc1 L_g1
    s_barrier
    v_mfma_f32_32x32x16_bf16 v[80:95], v[64:67], v[56:59], v[80:95]
    ds_read_b64_tr_b16 v[44:45], v8 offset:0
    ds_read_b64_tr_b16 v[46:47], v8 offset:768
    s_add_u32 s59, s40, 0
    buffer_load_dwordx4 v[184:187], v18, s[36:39], s59 offen offset:0 sc1
    v_mfma_f32_32x32x16_bf16 v[128:143], v[64:67], v[60:63], v[128:143]
    ds_read_b128 v[36:39], v4
    ds_read_b128 v[40:43], v4 offset:4096
    v_mfma_f32_32x32x16_bf16 v[96:111], v[68:71], v[56:59], v[96:111]
    ds_read_b64_tr_b16 v[48:49], v8 offset:32
    ds_read_b64_tr_b16 v[50:51], v8 offset:800
    buffer_load_dwordx4 v[188:191], v18, s[36:39], s59 offen offset:1024 sc1
    v_mfma_f32_32x32x16_bf16 v[144:159], v[68:71], v[60:63], v[144:159]
    ds_read_b64_tr_b16 v[52:53], v8 offset:64
    ds_read_b64_tr_b16 v[54:55], v8 offset:832
    v_mfma_f32_32x32x16_bf16 v[112:127], v[72:75], v[56:59], v[112:127]
    s_add_u32 s59, s40, 16384
    buffer_load_dwordx4 v[192:195], v18, s[36:39], s59 offen offset:0 sc1
    v_mfma_f32_32x32x16_bf16 v[160:175], v[72:75], v[60:63], v[160:175]
    buffer_load_dwordx4 v[196:199], v18, s[36:39], s59 offen offset:1024 sc1
    s_waitcnt lgkmcnt(0)
    v_mfma_f32_32x32x16_bf16 v[80:95], v[44:47], v[36:39], v[80:95]
    ds_read_b64_tr_b16 v[64:65], v8 offset:3072
    ds_read_b64_tr_b16 v[66:67], v8 offset:3840
    s_add_u32 s59, s40, 32768
    buffer_load_dwordx4 v[200:203], v18, s[36:39], s59 offen offset:0 sc1
    v_mfma_f32_32x32x16_bf16 v[128:143], v[44:47], v[40:43], v[128:143]
    ds_read_b128 v[56:59], v5
    ds_read_b128 v[60:63], v5 offset:4096
    v_mfma_f32_16x16x32_bf16 v[24:27], v[20:23], v[44:47], v[24:27]
    v_mfma_f32_32x32x16_bf16 v[96:111], v[48:51], v[36:39], v[96:111]
    ds_read_b64_tr_b16 v[68:69], v8 offset:3104
    ds_read_b64_tr_b16 v[70:71], v8 offset:3872
    buffer_load_dwordx4 v[204:207], v18, s[36:39], s59 offen offset:1024 sc1
    v_mfma_f32_32x32x16_bf16 v[144:159], v[48:51], v[40:43], v[144:159]
    ds_read_b64_tr_b16 v[72:73], v8 offset:3136
    ds_read_b64_tr_b16 v[74:75], v8 offset:3904
    v_mfma_f32_16x16x32_bf16 v[28:31], v[20:23], v[48:51], v[28:31]
    v_mfma_f32_32x32x16_bf16 v[112:127], v[52:55], v[36:39], v[112:127]
    s_add_u32 s59, s40, 49152
    buffer_load_dwordx4 v[208:211], v18, s[36:39], s59 offen offset:0 sc1
    v_mfma_f32_32x32x16_bf16 v[160:175], v[52:55], v[40:43], v[160:175]
    buffer_load_dwordx4 v[212:215], v18, s[36:39], s59 offen offset:1024 sc1
    v_mfma_f32_16x16x32_bf16 v[32:35], v[20:23], v[52:55], v[32:35]
    s_waitcnt lgkmcnt(0)
    v_mfma_f32_32x32x16_bf16 v[80:95], v[64:67], v[56:59], v[80:95]
    ds_read_b64_tr_b16 v[44:45], v9 offset:0
    ds_read_b64_tr_b16 v[46:47], v9 offset:768
    s_add_u32 s59, s40, 65536
    buffer_load_dwordx4 v[216:219], v18, s[36:39], s59 offen offset:0 sc1
    v_mfma_f32_32x32x16_bf16 v[128:143], v[64:67], v[60:63], v[128:143]
    ds_read_b128 v[36:39], v6
    ds_read_b128 v[40:43], v6 offset:4096
    v_mfma_f32_16x16x32_bf16 v[24:27], v[20:23], v[64:67], v[24:27]
    v_mfma_f32_32x32x16_bf16 v[96:111], v[68:71], v[56:59], v[96:111]
    ds_read_b64_tr_b16 v[48:49], v9 offset:32
    ds_read_b64_tr_b16 v[50:51], v9 offset:800
    buffer_load_dwordx4 v[240:243], v18, s[36:39], s59 offen offset:1024 sc1
    v_mfma_f32_32x32x16_bf16 v[144:159], v[68:71], v[60:63], v[144:159]
    ds_read_b64_tr_b16 v[52:53], v9 offset:64
    ds_read_b64_tr_b16 v[54:55], v9 offset:832
    v_mfma_f32_16x16x32_bf16 v[28:31], v[20:23], v[68:71], v[28:31]
    v_mfma_f32_32x32x16_bf16 v[112:127], v[72:75], v[56:59], v[112:127]
    v_mfma_f32_32x32x16_bf16 v[160:175], v[72:75], v[60:63], v[160:175]
    v_mfma_f32_16x16x32_bf16 v[32:35], v[20:23], v[72:75], v[32:35]
    s_waitcnt lgkmcnt(0)
    v_mfma_f32_32x32x16_bf16 v[80:95], v[44:47], v[36:39], v[80:95]
    ds_read_b64_tr_b16 v[64:65], v9 offset:3072
    ds_read_b64_tr_b16 v[66:67], v9 offset:3840
    v_mfma_f32_32x32x16_bf16 v[128:143], v[44:47], v[40:43], v[128:143]
    ds_read_b128 v[56:59], v7
    ds_read_b128 v[60:63], v7 offset:4096
    v_mfma_f32_32x32x16_bf16 v[96:111], v[48:51], v[36:39], v[96:111]
    ds_read_b64_tr_b16 v[68:69], v9 offset:3104
    ds_read_b64_tr_b16 v[70:71], v9 offset:3872
    v_mfma_f32_32x32x16_bf16 v[144:159], v[48:51], v[40:43], v[144:159]
    ds_read_b64_tr_b16 v[72:73], v9 offset:3136
    ds_read_b64_tr_b16 v[74:75], v9 offset:3904
    v_cvt_pk_bf16_f32 v20, v24, v24
    v_and_b32 v20, 0xffff0000, v20
    v_sub_f32 v21, v24, v20
    v_cvt_pk_bf16_f32 v220, v20, v21
    ds_write_b32 v16, v220 offset:0
    v_mfma_f32_32x32x16_bf16 v[112:127], v[52:55], v[36:39], v[112:127]
    v_cvt_pk_bf16_f32 v20, v28, v28
    v_and_b32 v20, 0xffff0000, v20
    v_sub_f32 v21, v28, v20
    v_cvt_pk_bf16_f32 v224, v20, v21
    ds_write_b32 v16, v224 offset:256
    v_mfma_f32_32x32x16_bf16 v[160:175], v[52:55], v[40:43], v[160:175]
    v_cvt_pk_bf16_f32 v20, v32, v32
    v_and_b32 v20, 0xffff0000, v20
    v_sub_f32 v21, v32, v20
    v_cvt_pk_bf16_f32 v228, v20, v21
    ds_write_b32 v16, v228 offset:512
    ds_write_b32 v10, v14 offset:0
    s_waitcnt lgkmcnt(4)
    v_mfma_f32_32x32x16_bf16 v[80:95], v[64:67], v[56:59], v[80:95]
    v_mfma_f32_32x32x16_bf16 v[128:143], v[64:67], v[60:63], v[128:143]
    ds_read_b128 v[4:7], v3 offset:16
    ds_read_b32 v8, v15 offset:0
    ds_read_b64 v[232:233], v19 offset:0
    v_mfma_f32_32x32x16_bf16 v[96:111], v[68:71], v[56:59], v[96:111]
    ds_read_b64 v[176:177], v19 offset:8
    ds_read_b64 v[236:237], v19 offset:512
    ds_read_b64 v[178:179], v19 offset:520
    v_mfma_f32_32x32x16_bf16 v[144:159], v[68:71], v[60:63], v[144:159]
    ds_read_b32 v221, v17 offset:0
    ds_read_b32 v225, v17 offset:256
    ds_read_b32 v229, v17 offset:512
    v_mfma_f32_32x32x16_bf16 v[112:127], v[72:75], v[56:59], v[112:127]
    v_mfma_f32_32x32x16_bf16 v[160:175], v[72:75], v[60:63], v[160:175]
    s_mov_b32 s61, 0x100000
    s_branch L_gx1
L_gx:
    ds_read_b128 v[4:7], v3 offset:16
    ds_read_b32 v8, v15 offset:0
    ds_read_b64 v[232:233], v19 offset:0
    ds_read_b64 v[176:177], v19 offset:8
    ds_read_b64 v[236:237], v19 offset:512
    ds_read_b64 v[178:179], v19 offset:520
    ds_read_b32 v221, v17 offset:0
    ds_read_b32 v225, v17 offset:256
    ds_read_b32 v229, v17 offset:512
L_gx1:
    s_sub_u32 s61, s61, 1
    s_waitcnt lgkmcnt(7)
    v_min3_u32 v4, v4, v5, v6
    v_min3_u32 v4, v4, v7, v8
    s_waitcnt lgkmcnt(0)
    v_readfirstlane_b32 s60, v4
    s_cbranch_scc1 L_gxd
    s_cmp_eq_u32 s60, 0
    s_cbranch_scc1 L_gx
L_gxd:
    v_mfma_f32_32x32x16_bf16 v[80:95], v[220:223], v[232:235], v[80:95]
    v_mfma_f32_32x32x16_bf16 v[128:143], v[220:223], v[236:239], v[128:143]
    v_mfma_f32_32x32x16_bf16 v[96:111], v[224:227], v[232:235], v[96:111]
    v_mfma_f32_32x32x16_bf16 v[144:159], v[224:227], v[236:239], v[144:159]
    v_mfma_f32_32x32x16_bf16 v[112:127], v[228:231], v[232:235], v[112:127]
    v_mfma_f32_32x32x16_bf16 v[160:175], v[228:231], v[236:239], v[160:175]
    s_add_u32 s59, s41, 0
    buffer_load_dwordx4 v[244:247], v18, s[36:39], s59 offen offset:0 sc1
    buffer_load_dwordx4 v[248:251], v18, s[36:39], s59 offen offset:1024 sc1
    s_nop 6
    s_mov_b32 s58, 0
    v_pk_mul_f32 v[80:81], v[80:81], v[176:177] op_sel:[0,1] op_sel_hi:[1,1]
    v_pk_mul_f32 v[82:83], v[82:83], v[176:177] op_sel:[0,1] op_sel_hi:[1,1]
    v_pk_mul_f32 v[84:85], v[84:85], v[176:177] op_sel:[0,1] op_sel_hi:[1,1]
    v_pk_mul_f32 v[86:87], v[86:87], v[176:177] op_sel:[0,1] op_sel_hi:[1,1]
    v_exp_f32 v80, v80
    v_exp_f32 v81, v81
    v_exp_f32 v82, v82
    v_exp_f32 v83, v83
    v_exp_f32 v84, v84
    v_exp_f32 v85, v85
    v_exp_f32 v86, v86
    v_exp_f32 v87, v87
    v_pk_fma_f32 v[80:81], v[80:81], v[176:177], v[176:177] op_sel:[0,0,0] op_sel_hi:[1,0,0]
    v_pk_fma_f32 v[82:83], v[82:83], v[176:177], v[176:177] op_sel:[0,0,0] op_sel_hi:[1,0,0]
    v_pk_fma_f32 v[84:85], v[84:85], v[176:177], v[176:177] op_sel:[0,0,0] op_sel_hi:[1,0,0]
    v_pk_fma_f32 v[86:87], v[86:87], v[176:177], v[176:177] op_sel:[0,0,0] op_sel_hi:[1,0,0]
    v_rcp_f32 v80, v80
    v_rcp_f32 v81, v81
    v_rcp_f32 v82, v82
    v_rcp_f32 v83, v83
    v_rcp_f32 v84, v84
    v_rcp_f32 v85, v85
    v_rcp_f32 v86, v86
    v_rcp_f32 v87, v87
    v_pk_mul_f32 v[80:81], v[80:81], v[88:89]
    v_pk_mul_f32 v[82:83], v[82:83], v[90:91]
    v_pk_mul_f32 v[84:85], v[84:85], v[92:93]
    v_pk_mul_f32 v[86:87], v[86:87], v[94:95]
    v_cvt_pk_bf16_f32 v88, v80, v81
    v_cvt_pk_bf16_f32 v89, v82, v83
    v_cvt_pk_bf16_f32 v90, v84, v85
    v_cvt_pk_bf16_f32 v91, v86, v87
    buffer_store_dwordx4 v[88:91], v2, s[44:47], s58 offen offset:0 sc1
    s_add_u32 s59, s41, 16384
    buffer_load_dwordx4 v[252:255], v18, s[36:39], s59 offen offset:0 sc1
    buffer_load_dwordx4 v[180:183], v18, s[36:39], s59 offen offset:1024 sc1
    v_pk_mul_f32 v[128:129], v[128:129], v[178:179] op_sel:[0,1] op_sel_hi:[1,1]
    v_pk_mul_f32 v[130:131], v[130:131], v[178:179] op_sel:[0,1] op_sel_hi:[1,1]
    v_pk_mul_f32 v[132:133], v[132:133], v[178:179] op_sel:[0,1] op_sel_hi:[1,1]
    v_pk_mul_f32 v[134:135], v[134:135], v[178:179] op_sel:[0,1] op_sel_hi:[1,1]
    v_exp_f32 v128, v128
    v_exp_f32 v129, v129
    v_exp_f32 v130, v130
    v_exp_f32 v131, v131
    v_exp_f32 v132, v132
    v_exp_f32 v133, v133
    v_exp_f32 v134, v134
    v_exp_f32 v135, v135
    v_pk_fma_f32 v[128:129], v[128:129], v[178:179], v[178:179] op_sel:[0,0,0] op_sel_hi:[1,0,0]
    v_pk_fma_f32 v[130:131], v[130:131], v[178:179], v[178:179] op_sel:[0,0,0] op_sel_hi:[1,0,0]
    v_pk_fma_f32 v[132:133], v[132:133], v[178:179], v[178:179] op_sel:[0,0,0] op_sel_hi:[1,0,0]
    v_pk_fma_f32 v[134:135], v[134:135], v[178:179], v[178:179] op_sel:[0,0,0] op_sel_hi:[1,0,0]
    v_rcp_f32 v128, v128
    v_rcp_f32 v129, v129
    v_rcp_f32 v130, v130
    v_rcp_f32 v131, v131
    v_rcp_f32 v132, v132
    v_rcp_f32 v133, v133
    v_rcp_f32 v134, v134
    v_rcp_f32 v135, v135
    v_pk_mul_f32 v[128:129], v[128:129], v[136:137]
    v_pk_mul_f32 v[130:131], v[130:131], v[138:139]
    v_pk_mul_f32 v[132:133], v[132:133], v[140:141]
    v_pk_mul_f32 v[134:135], v[134:135], v[142:143]
    v_cvt_pk_bf16_f32 v136, v128, v129
    v_cvt_pk_bf16_f32 v137, v130, v131
    v_cvt_pk_bf16_f32 v138, v132, v133
    v_cvt_pk_bf16_f32 v139, v134, v135
    buffer_store_dwordx4 v[136:139], v2, s[44:47], s58 offen offset:1024 sc1
    s_mov_b32 s58, 65536
    v_pk_mul_f32 v[96:97], v[96:97], v[176:177] op_sel:[0,1] op_sel_hi:[1,1]
    v_pk_mul_f32 v[98:99], v[98:99], v[176:177] op_sel:[0,1] op_sel_hi:[1,1]
    v_pk_mul_f32 v[100:101], v[100:101], v[176:177] op_sel:[0,1] op_sel_hi:[1,1]
    v_pk_mul_f32 v[102:103], v[102:103], v[176:177] op_sel:[0,1] op_sel_hi:[1,1]
    v_exp_f32 v96, v96
    v_exp_f32 v97, v97
    v_exp_f32 v98, v98
    v_exp_f32 v99, v99
    v_exp_f32 v100, v100
    v_exp_f32 v101, v101
    v_exp_f32 v102, v102
    v_exp_f32 v103, v103
    v_pk_fma_f32 v[96:97], v[96:97], v[176:177], v[176:177] op_sel:[0,0,0] op_sel_hi:[1,0,0]
    v_pk_fma_f32 v[98:99], v[98:99], v[176:177], v[176:177] op_sel:[0,0,0] op_sel_hi:[1,0,0]
    v_pk_fma_f32 v[100:101], v[100:101], v[176:177], v[176:177] op_sel:[0,0,0] op_sel_hi:[1,0,0]
    v_pk_fma_f32 v[102:103], v[102:103], v[176:177], v[176:177] op_sel:[0,0,0] op_sel_hi:[1,0,0]
    v_rcp_f32 v96, v96
    v_rcp_f32 v97, v97
    v_rcp_f32 v98, v98
    v_rcp_f32 v99, v99
    v_rcp_f32 v100, v100
    v_rcp_f32 v101, v101
    v_rcp_f32 v102, v102
    v_rcp_f32 v103, v103
    v_pk_mul_f32 v[96:97], v[96:97], v[104:105]
    v_pk_mul_f32 v[98:99], v[98:99], v[106:107]
    v_pk_mul_f32 v[100:101], v[100:101], v[108:109]
    v_pk_mul_f32 v[102:103], v[102:103], v[110:111]
    v_cvt_pk_bf16_f32 v104, v96, v97
    v_cvt_pk_bf16_f32 v105, v98, v99
    v_cvt_pk_bf16_f32 v106, v100, v101
    v_cvt_pk_bf16_f32 v107, v102, v103
    buffer_store_dwordx4 v[104:107], v2, s[44:47], s58 offen offset:0 sc1
    v_pk_mul_f32 v[144:145], v[144:145], v[178:179] op_sel:[0,1] op_sel_hi:[1,1]
    v_pk_mul_f32 v[146:147], v[146:147], v[178:179] op_sel:[0,1] op_sel_hi:[1,1]
    v_pk_mul_f32 v[148:149], v[148:149], v[178:179] op_sel:[0,1] op_sel_hi:[1,1]
    v_pk_mul_f32 v[150:151], v[150:151], v[178:179] op_sel:[0,1] op_sel_hi:[1,1]
    v_exp_f32 v144, v144
    v_exp_f32 v145, v145
    v_exp_f32 v146, v146
    v_exp_f32 v147, v147
    v_exp_f32 v148, v148
    v_exp_f32 v149, v149
    v_exp_f32 v150, v150
    v_exp_f32 v151, v151
    v_pk_fma_f32 v[144:145], v[144:145], v[178:179], v[178:179] op_sel:[0,0,0] op_sel_hi:[1,0,0]
    v_pk_fma_f32 v[146:147], v[146:147], v[178:179], v[178:179] op_sel:[0,0,0] op_sel_hi:[1,0,0]
    v_pk_fma_f32 v[148:149], v[148:149], v[178:179], v[178:179] op_sel:[0,0,0] op_sel_hi:[1,0,0]
    v_pk_fma_f32 v[150:151], v[150:151], v[178:179], v[178:179] op_sel:[0,0,0] op_sel_hi:[1,0,0]
    v_rcp_f32 v144, v144
    v_rcp_f32 v145, v145
    v_rcp_f32 v146, v146
    v_rcp_f32 v147, v147
    v_rcp_f32 v148, v148
    v_rcp_f32 v149, v149
    v_rcp_f32 v150, v150
    v_rcp_f32 v151, v151
    v_pk_mul_f32 v[144:145], v[144:145], v[152:153]
    v_pk_mul_f32 v[146:147], v[146:147], v[154:155]
    v_pk_mul_f32 v[148:149], v[148:149], v[156:157]
    v_pk_mul_f32 v[150:151], v[150:151], v[158:159]
    v_cvt_pk_bf16_f32 v152, v144, v145
    v_cvt_pk_bf16_f32 v153, v146, v147
    v_cvt_pk_bf16_f32 v154, v148, v149
    v_cvt_pk_bf16_f32 v155, v150, v151
    buffer_store_dwordx4 v[152:155], v2, s[44:47], s58 offen offset:1024 sc1
    s_mov_b32 s58, 131072
    v_pk_mul_f32 v[112:113], v[112:113], v[176:177] op_sel:[0,1] op_sel_hi:[1,1]
    v_pk_mul_f32 v[114:115], v[114:115], v[176:177] op_sel:[0,1] op_sel_hi:[1,1]
    v_pk_mul_f32 v[116:117], v[116:117], v[176:177] op_sel:[0,1] op_sel_hi:[1,1]
    v_pk_mul_f32 v[118:119], v[118:119], v[176:177] op_sel:[0,1] op_sel_hi:[1,1]
    v_exp_f32 v112, v112
    v_exp_f32 v113, v113
    v_exp_f32 v114, v114
    v_exp_f32 v115, v115
    v_exp_f32 v116, v116
    v_exp_f32 v117, v117
    v_exp_f32 v118, v118
    v_exp_f32 v119, v119
    v_pk_fma_f32 v[112:113], v[112:113], v[176:177], v[176:177] op_sel:[0,0,0] op_sel_hi:[1,0,0]
    v_pk_fma_f32 v[114:115], v[114:115], v[176:177], v[176:177] op_sel:[0,0,0] op_sel_hi:[1,0,0]
    v_pk_fma_f32 v[116:117], v[116:117], v[176:177], v[176:177] op_sel:[0,0,0] op_sel_hi:[1,0,0]
    v_pk_fma_f32 v[118:119], v[118:119], v[176:177], v[176:177] op_sel:[0,0,0] op_sel_hi:[1,0,0]
    v_rcp_f32 v112, v112
    v_rcp_f32 v113, v113
    v_rcp_f32 v114, v114
    v_rcp_f32 v115, v115
    v_rcp_f32 v116, v116
    v_rcp_f32 v117, v117
    v_rcp_f32 v118, v118
    v_rcp_f32 v119, v119
    v_pk_mul_f32 v[112:113], v[112:113], v[120:121]
    v_pk_mul_f32 v[114:115], v[114:115], v[122:123]
    v_pk_mul_f32 v[116:117], v[116:117], v[124:125]
    v_pk_mul_f32 v[118:119], v[118:119], v[126:127]
    v_cvt_pk_bf16_f32 v120, v112, v113
    v_cvt_pk_bf16_f32 v121, v114, v115
    v_cvt_pk_bf16_f32 v122, v116, v117
    v_cvt_pk_bf16_f32 v123, v118, v119
    buffer_store_dwordx4 v[120:123], v2, s[44:47], s58 offen offset:0 sc1
    v_pk_mul_f32 v[160:161], v[160:161], v[178:179] op_sel:[0,1] op_sel_hi:[1,1]
    v_pk_mul_f32 v[162:163], v[162:163], v[178:179] op_sel:[0,1] op_sel_hi:[1,1]
    v_pk_mul_f32 v[164:165], v[164:165], v[178:179] op_sel:[0,1] op_sel_hi:[1,1]
    v_pk_mul_f32 v[166:167], v[166:167], v[178:179] op_sel:[0,1] op_sel_hi:[1,1]
    v_exp_f32 v160, v160
    v_exp_f32 v161, v161
    v_exp_f32 v162, v162
    v_exp_f32 v163, v163
    v_exp_f32 v164, v164
    v_exp_f32 v165, v165
    v_exp_f32 v166, v166
    v_exp_f32 v167, v167
    v_pk_fma_f32 v[160:161], v[160:161], v[178:179], v[178:179] op_sel:[0,0,0] op_sel_hi:[1,0,0]
    v_pk_fma_f32 v[162:163], v[162:163], v[178:179], v[178:179] op_sel:[0,0,0] op_sel_hi:[1,0,0]
    v_pk_fma_f32 v[164:165], v[164:165], v[178:179], v[178:179] op_sel:[0,0,0] op_sel_hi:[1,0,0]
    v_pk_fma_f32 v[166:167], v[166:167], v[178:179], v[178:179] op_sel:[0,0,0] op_sel_hi:[1,0,0]
    v_rcp_f32 v160, v160
    v_rcp_f32 v161, v161
    v_rcp_f32 v162, v162
    v_rcp_f32 v163, v163
    v_rcp_f32 v164, v164
    v_rcp_f32 v165, v165
    v_rcp_f32 v166, v166
    v_rcp_f32 v167, v167
    v_pk_mul_f32 v[160:161], v[160:161], v[168:169]
    v_pk_mul_f32 v[162:163], v[162:163], v[170:171]
    v_pk_mul_f32 v[164:165], v[164:165], v[172:173]
    v_pk_mul_f32 v[166:167], v[166:167], v[174:175]
    v_cvt_pk_bf16_f32 v168, v160, v161
    v_cvt_pk_bf16_f32 v169, v162, v163
    v_cvt_pk_bf16_f32 v170, v164, v165
    v_cvt_pk_bf16_f32 v171, v166, v167
    buffer_store_dwordx4 v[168:171], v2, s[44:47], s58 offen offset:1024 sc1
L_g2:
    s_barrier
    s_add_u32 m0, s68, 0
    s_add_u32 s58, s42, 16384
    buffer_load_dwordx4 v18, s[36:39], s58 offen sc1 lds
    buffer_load_dwordx4 v18, s[36:39], s58 offen offset:1024 sc1 lds
    s_add_u32 m0, s68, 2048
    s_add_u32 s58, s42, 32768
    buffer_load_dwordx4 v18, s[36:39], s58 offen sc1 lds
    buffer_load_dwordx4 v18, s[36:39], s58 offen offset:1024 sc1 lds
    s_add_u32 m0, s68, 4096
    s_add_u32 s58, s42, 49152
    buffer_load_dwordx4 v18, s[36:39], s58 offen sc1 lds
    buffer_load_dwordx4 v18, s[36:39], s58 offen offset:1024 sc1 lds
    s_add_u32 m0, s68, 6144
    s_add_u32 s58, s42, 65536
    buffer_load_dwordx4 v18, s[36:39], s58 offen sc1 lds
    buffer_load_dwordx4 v18, s[36:39], s58 offen offset:1024 sc1 lds
    s_lshl_b32 s58, s53, 11
    s_add_u32 s58, s58, 10551296
    v_lshl_add_u32 v4, v1, 7, s58
    s_waitcnt vmcnt(28)
    v_lshlrev_b32 v60, 16, v76
    v_and_b32 v61, 0xffff0000, v76
    v_lshlrev_b32 v62, 16, v77
    v_and_b32 v63, 0xffff0000, v77
    v_lshlrev_b32 v64, 16, v78
    v_and_b32 v65, 0xffff0000, v78
    v_lshlrev_b32 v66, 16, v79
    v_and_b32 v67, 0xffff0000, v79
    v_mov_b32 v68, v11
    v_and_b32 v72, 15, v1
    v_lshrrev_b32 v73, 4, v1
    s_lshr_b32 s59, s52, 2
    s_and_b32 s58, s52, 1
    s_lshl1_add_u32 s58, s59, s58
    s_bfe_u32 s59, s52, 0x10001
    s_lshl_b32 s60, s59, 3
    v_lshl_add_u32 v69, v73, 1, s60
    v_xor_b32 v69, v69, v72
    s_and_b32 s60, s52, 1
    s_lshl_b32 s60, s60, 12
    s_cmp_lt_u32 s52, 4
    s_cselect_b32 s61, 22528, 0
    s_add_u32 s60, s60, s61
    v_lshl_add_u32 v72, v72, 8, s60
    v_lshl_add_u32 v69, v69, 4, v72
    v_xor_b32 v70, 16, v69
    v_add_u32 v74, 61440, v69
    v_add_u32 v75, 61440, v70
    v_bfe_u32 v71, v1, 2, 2
    v_lshl_add_u32 v71, v73, 3, v71
    v_mul_u32_u24 v71, 144, v71
    v_and_b32 v72, 3, v1
    v_lshl_add_u32 v71, v72, 3, v71
    s_mul_i32 s60, s59, 14592
    s_lshl_b32 s61, s58, 5
    s_add_u32 s60, s60, s61
    s_add_u32 s60, s60, 123264
    v_add_u32 v71, s60, v71
    v_lshl_add_u32 v9, v1, 4, s68
    v_mov_b32 v8, 10
    s_lshl_b32 s58, s55, 3
    s_add_u32 s58, s58, s56
    s_lshl_b32 s58, s58, 7
    s_add_u32 s58, s58, 10551296
    v_mov_b32 v5, s58
    s_mul_i32 s58, s62, 1441792
    s_lshl_b32 s59, s55, 11
    s_add_u32 s58, s58, s59
    v_lshl_add_u32 v7, v1, 4, s58
    s_waitcnt vmcnt(8)
    s_cmp_lg_u32 s62, 0
    s_barrier
    s_cbranch_scc1 L_pb
    s_mov_b64 exec, 0xffff
    global_atomic_add v4, v13, s[34:35] sc1
    s_mov_b64 exec, -1
L_pb:
    s_add_u32 m0, s68, 8192
    s_add_u32 s58, s43, 0
    buffer_load_dwordx4 v18, s[36:39], s58 offen sc1 lds
    buffer_load_dwordx4 v18, s[36:39], s58 offen offset:1024 sc1 lds
    s_add_u32 m0, s68, 10240
    s_add_u32 s58, s43, 16384
    buffer_load_dwordx4 v18, s[36:39], s58 offen sc1 lds
    buffer_load_dwordx4 v18, s[36:39], s58 offen offset:1024 sc1 lds
    s_add_u32 m0, s68, 12288
    s_add_u32 s58, s43, 32768
    buffer_load_dwordx4 v18, s[36:39], s58 offen sc1 lds
    buffer_load_dwordx4 v18, s[36:39], s58 offen offset:1024 sc1 lds
    s_add_u32 m0, s68, 14336
    s_add_u32 s58, s43, 49152
    buffer_load_dwordx4 v18, s[36:39], s58 offen sc1 lds
    buffer_load_dwordx4 v18, s[36:39], s58 offen offset:1024 sc1 lds
    s_add_u32 m0, s68, 16384
    s_add_u32 s58, s43, 65536
    buffer_load_dwordx4 v18, s[36:39], s58 offen sc1 lds
    buffer_load_dwordx4 v18, s[36:39], s58 offen offset:1024 sc1 lds
    s_add_u32 m0, s68, 18432
    s_add_u32 s58, s43, 81920
    buffer_load_dwordx4 v18, s[36:39], s58 offen sc1 lds
    buffer_load_dwordx4 v18, s[36:39], s58 offen offset:1024 sc1 lds
    global_load_dword v6, v5, s[34:35] sc1
    s_add_u32 m0, s68, 20480
    s_add_u32 s58, s43, 98304
    buffer_load_dwordx4 v18, s[36:39], s58 offen sc1 lds
    buffer_load_dwordx4 v18, s[36:39], s58 offen offset:1024 sc1 lds
    s_add_u32 s59, s41, 32768
    buffer_load_dwordx4 v[36:39], v18, s[36:39], s59 offen offset:0 sc1
    buffer_load_dwordx4 v[40:43], v18, s[36:39], s59 offen offset:1024 sc1
    s_add_u32 s59, s41, 49152
    buffer_load_dwordx4 v[44:47], v18, s[36:39], s59 offen offset:0 sc1
    buffer_load_dwordx4 v[48:51], v18, s[36:39], s59 offen offset:1024 sc1
    s_add_u32 s59, s41, 65536
    buffer_load_dwordx4 v[52:55], v18, s[36:39], s59 offen offset:0 sc1
    buffer_load_dwordx4 v[24:27], v18, s[36:39], s59 offen offset:1024 sc1
    s_add_u32 s59, s42, 0
    buffer_load_dwordx4 v[28:31], v18, s[36:39], s59 offen offset:0 sc1
    buffer_load_dwordx4 v[32:35], v18, s[36:39], s59 offen offset:1024 sc1
    s_lshl_b32 s40, s40, 2
    s_lshl_b32 s41, s41, 2
    s_lshl_b32 s42, s42, 2
    s_lshl_b32 s43, s43, 2
    v_lshrrev_b32 v76, 5, v1
    v_and_b32 v77, 15, v1
    v_xor_b32 v76, v76, v77
    v_and_b32 v77, 31, v1
    v_lshl_add_u32 v77, v77, 8, s68
    v_lshl_add_u32 v12, v76, 4, v77
    v_xor_b32 v13, 32, v12
    v_xor_b32 v14, 64, v12
    v_xor_b32 v15, 96, v12
    v_xor_b32 v16, 128, v12
    v_xor_b32 v17, 160, v12
    v_xor_b32 v18, 192, v12
    v_xor_b32 v19, 224, v12
    s_waitcnt vmcnt(10)
    v_cmp_gt_u32 vcc, 16, v6
    s_nop 1
    s_cbranch_vccz L_h2
    s_mov_b32 s61, 0x20000
L_p8:
    global_load_dword v6, v5, s[34:35] sc1
    s_sub_u32 s61, s61, 1
    s_waitcnt vmcnt(0)
    v_cmp_gt_u32 vcc, 16, v6
    s_cbranch_scc1 L_p8d
    s_nop 0
    s_cbranch_vccz L_p8d
    s_sleep 1
    s_branch L_p8
L_p8d:
L_h2:
    s_add_u32 s58, s40, 0
    buffer_load_dwordx4 v[80:83], v7, s[44:47], s58 offen offset:0 sc1
    s_add_u32 s58, s40, 65536
    buffer_load_dwordx4 v[84:87], v7, s[44:47], s58 offen offset:0 sc1
    s_add_u32 s58, s40, 131072
    buffer_load_dwordx4 v[88:91], v7, s[44:47], s58 offen offset:0 sc1
    s_add_u32 s58, s40, 196608
    buffer_load_dwordx4 v[92:95], v7, s[44:47], s58 offen offset:0 sc1
    s_add_u32 s58, s40, 262144
    buffer_load_dwordx4 v[128:131], v7, s[44:47], s58 offen offset:0 sc1
    s_add_u32 s58, s41, 0
    buffer_load_dwordx4 v[132:135], v7, s[44:47], s58 offen offset:0 sc1
    s_add_u32 s58, s41, 65536
    buffer_load_dwordx4 v[136:139], v7, s[44:47], s58 offen offset:0 sc1
    s_add_u32 s58, s41, 131072
    buffer_load_dwordx4 v[140:143], v7, s[44:47], s58 offen offset:0 sc1
    s_add_u32 s58, s41, 196608
    buffer_load_dwordx4 v[220:223], v7, s[44:47], s58 offen offset:0 sc1
    s_add_u32 s58, s41, 262144
    buffer_load_dwordx4 v[224:227], v7, s[44:47], s58 offen offset:0 sc1
    s_waitcnt vmcnt(9)
    v_mfma_f32_32x32x16_bf16 v[96:111], v[184:187], v[80:83], 0
    s_add_u32 s58, s42, 0
    v_mfma_f32_32x32x16_bf16 v[144:159], v[188:191], v[80:83], 0
    buffer_load_dwordx4 v[80:83], v7, s[44:47], s58 offen offset:0 sc1
    s_waitcnt vmcnt(9)
    v_mfma_f32_32x32x16_bf16 v[96:111], v[192:195], v[84:87], v[96:111]
    s_add_u32 s58, s42, 65536
    v_mfma_f32_32x32x16_bf16 v[144:159], v[196:199], v[84:87], v[144:159]
    buffer_load_dwordx4 v[84:87], v7, s[44:47], s58 offen offset:0 sc1
    s_waitcnt vmcnt(9)
    v_mfma_f32_32x32x16_bf16 v[96:111], v[200:203], v[88:91], v[96:111]
    s_add_u32 s58, s42, 131072
    v_mfma_f32_32x32x16_bf16 v[144:159], v[204:207], v[88:91], v[144:159]
    buffer_load_dwordx4 v[88:91], v7, s[44:47], s58 offen offset:0 sc1
    s_waitcnt vmcnt(9)
    v_mfma_f32_32x32x16_bf16 v[96:111], v[208:211], v[92:95], v[96:111]
    s_add_u32 s58, s42, 196608
    v_mfma_f32_32x32x16_bf16 v[144:159], v[212:215], v[92:95], v[144:159]
    buffer_load_dwordx4 v[92:95], v7, s[44:47], s58 offen offset:0 sc1
    s_waitcnt vmcnt(9)
    v_mfma_f32_32x32x16_bf16 v[96:111], v[216:219], v[128:131], v[96:111]
    s_add_u32 s58, s42, 262144
    v_mfma_f32_32x32x16_bf16 v[144:159], v[240:243], v[128:131], v[144:159]
    buffer_load_dwordx4 v[128:131], v7, s[44:47], s58 offen offset:0 sc1
    s_waitcnt vmcnt(9)
    v_mfma_f32_32x32x16_bf16 v[96:111], v[244:247], v[132:135], v[96:111]
    s_add_u32 s58, s43, 0
    v_mfma_f32_32x32x16_bf16 v[144:159], v[248:251], v[132:135], v[144:159]
    buffer_load_dwordx4 v[132:135], v7, s[44:47], s58 offen offset:0 sc1
    s_waitcnt vmcnt(9)
    v_mfma_f32_32x32x16_bf16 v[96:111], v[252:255], v[136:139], v[96:111]
    s_add_u32 s58, s43, 65536
    v_mfma_f32_32x32x16_bf16 v[144:159], v[180:183], v[136:139], v[144:159]
    buffer_load_dwordx4 v[136:139], v7, s[44:47], s58 offen offset:0 sc1
    s_waitcnt vmcnt(9)
    v_mfma_f32_32x32x16_bf16 v[96:111], v[36:39], v[140:143], v[96:111]
    s_add_u32 s58, s43, 131072
    v_mfma_f32_32x32x16_bf16 v[144:159], v[40:43], v[140:143], v[144:159]
    buffer_load_dwordx4 v[140:143], v7, s[44:47], s58 offen offset:0 sc1
    s_waitcnt vmcnt(9)
    v_mfma_f32_32x32x16_bf16 v[96:111], v[44:47], v[220:223], v[96:111]
    s_add_u32 s58, s43, 196608
    v_mfma_f32_32x32x16_bf16 v[144:159], v[48:51], v[220:223], v[144:159]
    buffer_load_dwordx4 v[220:223], v7, s[44:47], s58 offen offset:0 sc1
    s_waitcnt vmcnt(9)
    v_mfma_f32_32x32x16_bf16 v[96:111], v[52:55], v[224:227], v[96:111]
    ds_read_b128 v[112:115], v9 offset:0
    ds_read_b128 v[116:119], v9 offset:1024
    s_add_u32 s58, s43, 262144
    v_mfma_f32_32x32x16_bf16 v[144:159], v[24:27], v[224:227], v[144:159]
    buffer_load_dwordx4 v[224:227], v7, s[44:47], s58 offen offset:0 sc1
    s_waitcnt vmcnt(9)
    v_mfma_f32_32x32x16_bf16 v[96:111], v[28:31], v[80:83], v[96:111]
    ds_read_b128 v[236:239], v9 offset:2048
    ds_read_b128 v[176:179], v9 offset:3072
    s_add_u32 s58, s43, 327680
    v_mfma_f32_32x32x16_bf16 v[144:159], v[32:35], v[80:83], v[144:159]
    buffer_load_dwordx4 v[80:83], v7, s[44:47], s58 offen offset:0 sc1
    s_waitcnt vmcnt(9) lgkmcnt(2)
    v_mfma_f32_32x32x16_bf16 v[96:111], v[112:115], v[84:87], v[96:111]
    ds_read_b128 v[20:23], v9 offset:4096
    ds_read_b128 v[56:59], v9 offset:5120
    s_add_u32 s58, s43, 393216
    v_mfma_f32_32x32x16_bf16 v[144:159], v[116:119], v[84:87], v[144:159]
    buffer_load_dwordx4 v[84:87], v7, s[44:47], s58 offen offset:0 sc1
    s_waitcnt vmcnt(9) lgkmcnt(2)
    v_mfma_f32_32x32x16_bf16 v[96:111], v[236:239], v[88:91], v[96:111]
    ds_read_b128 v[112:115], v9 offset:6144
    ds_read_b128 v[116:119], v9 offset:7168
    s_add_u32 s58, s40, 0
    v_mfma_f32_32x32x16_bf16 v[144:159], v[176:179], v[88:91], v[144:159]
    buffer_load_dwordx4 v[88:91], v7, s[44:47], s58 offen offset:1024 sc1
    s_waitcnt vmcnt(9) lgkmcnt(2)
    v_mfma_f32_32x32x16_bf16 v[96:111], v[20:23], v[92:95], v[96:111]
    ds_read_b128 v[236:239], v9 offset:8192
    ds_read_b128 v[176:179], v9 offset:9216
    s_add_u32 s58, s40, 65536
    v_mfma_f32_32x32x16_bf16 v[144:159], v[56:59], v[92:95], v[144:159]
    buffer_load_dwordx4 v[92:95], v7, s[44:47], s58 offen offset:1024 sc1
    s_waitcnt vmcnt(9) lgkmcnt(2)
    v_mfma_f32_32x32x16_bf16 v[96:111], v[112:115], v[128:131], v[96:111]
    ds_read_b128 v[20:23], v9 offset:10240
    ds_read_b128 v[56:59], v9 offset:11264
    s_add_u32 s58, s40, 131072
    v_mfma_f32_32x32x16_bf16 v[144:159], v[116:119], v[128:131], v[144:159]
    buffer_load_dwordx4 v[128:131], v7, s[44:47], s58 offen offset:1024 sc1
    s_waitcnt vmcnt(9) lgkmcnt(2)
    v_mfma_f32_32x32x16_bf16 v[96:111], v[236:239], v[132:135], v[96:111]
    ds_read_b128 v[112:115], v9 offset:12288
    ds_read_b128 v[116:119], v9 offset:13312
    s_add_u32 s58, s40, 196608
    v_mfma_f32_32x32x16_bf16 v[144:159], v[176:179], v[132:135], v[144:159]
    buffer_load_dwordx4 v[132:135], v7, s[44:47], s58 offen offset:1024 sc1
    s_waitcnt vmcnt(9) lgkmcnt(2)
    v_mfma_f32_32x32x16_bf16 v[96:111], v[20:23], v[136:139], v[96:111]
    ds_read_b128 v[236:239], v9 offset:14336
    ds_read_b128 v[176:179], v9 offset:15360
    s_add_u32 s58, s40, 262144
    v_mfma_f32_32x32x16_bf16 v[144:159], v[56:59], v[136:139], v[144:159]
    buffer_load_dwordx4 v[136:139], v7, s[44:47], s58 offen offset:1024 sc1
    s_waitcnt vmcnt(9) lgkmcnt(2)
    v_mfma_f32_32x32x16_bf16 v[96:111], v[112:115], v[140:143], v[96:111]
    ds_read_b128 v[20:23], v9 offset:16384
    ds_read_b128 v[56:59], v9 offset:17408
    s_add_u32 s58, s41, 0
    v_mfma_f32_32x32x16_bf16 v[144:159], v[116:119], v[140:143], v[144:159]
    buffer_load_dwordx4 v[140:143], v7, s[44:47], s58 offen offset:1024 sc1
    s_waitcnt vmcnt(9) lgkmcnt(2)
    v_mfma_f32_32x32x16_bf16 v[96:111], v[236:239], v[220:223], v[96:111]
    ds_read_b128 v[112:115], v9 offset:18432
    ds_read_b128 v[116:119], v9 offset:19456
    s_add_u32 s58, s41, 65536
    v_mfma_f32_32x32x16_bf16 v[144:159], v[176:179], v[220:223], v[144:159]
    buffer_load_dwordx4 v[220:223], v7, s[44:47], s58 offen offset:1024 sc1
    s_waitcnt vmcnt(9) lgkmcnt(2)
    v_mfma_f32_32x32x16_bf16 v[96:111], v[20:23], v[224:227], v[96:111]
    ds_read_b128 v[236:239], v9 offset:20480
    ds_read_b128 v[176:179], v9 offset:21504
    s_add_u32 s58, s41, 131072
    v_mfma_f32_32x32x16_bf16 v[144:159], v[56:59], v[224:227], v[144:159]
    buffer_load_dwordx4 v[224:227], v7, s[44:47], s58 offen offset:1024 sc1
    s_waitcnt vmcnt(9) lgkmcnt(2)
    v_mfma_f32_32x32x16_bf16 v[96:111], v[112:115], v[80:83], v[96:111]
    s_add_u32 s58, s41, 196608
    v_mfma_f32_32x32x16_bf16 v[144:159], v[116:119], v[80:83], v[144:159]
    buffer_load_dwordx4 v[80:83], v7, s[44:47], s58 offen offset:1024 sc1
    s_waitcnt vmcnt(9) lgkmcnt(0)
    v_mfma_f32_32x32x16_bf16 v[96:111], v[236:239], v[84:87], v[96:111]
    s_add_u32 s58, s41, 262144
    ds_read_b128 v[76:79], v3 offset:16
    v_mfma_f32_32x32x16_bf16 v[144:159], v[176:179], v[84:87], v[144:159]
    buffer_load_dwordx4 v[84:87], v7, s[44:47], s58 offen offset:1024 sc1
    s_waitcnt vmcnt(9)
    v_mfma_f32_32x32x16_bf16 v[112:127], v[184:187], v[88:91], 0
    s_add_u32 s58, s42, 0
    v_mfma_f32_32x32x16_bf16 v[160:175], v[188:191], v[88:91], 0
    buffer_load_dwordx4 v[88:91], v7, s[44:47], s58 offen offset:1024 sc1
    s_waitcnt vmcnt(9)
    v_mfma_f32_32x32x16_bf16 v[112:127], v[192:195], v[92:95], v[112:127]
    s_add_u32 s58, s42, 65536
    s_waitcnt lgkmcnt(0)
    v_min3_u32 v76, v76, v77, v78
    v_min_u32 v76, v76, v79
    v_cmp_gt_u32 vcc, 2, v76
    v_mfma_f32_32x32x16_bf16 v[160:175], v[196:199], v[92:95], v[160:175]
    buffer_load_dwordx4 v[92:95], v7, s[44:47], s58 offen offset:1024 sc1
    s_cbranch_vccz L_pa
    s_mov_b32 s61, 0x100000
L_w9:
    ds_read_b128 v[76:79], v3 offset:16
    s_sub_u32 s61, s61, 1
    s_waitcnt lgkmcnt(0)
    v_min3_u32 v76, v76, v77, v78
    v_min_u32 v76, v76, v79
    s_nop 0
    v_readfirstlane_b32 s60, v76
    s_cbranch_scc1 L_w9d
    s_cmp_lt_u32 s60, 2
    s_cbranch_scc1 L_w9
L_w9d:
L_pa:
    s_waitcnt vmcnt(9)
    v_mfma_f32_32x32x16_bf16 v[112:127], v[200:203], v[128:131], v[112:127]
    s_add_u32 s58, s42, 131072
    ds_write_b128 v12, v[96:99] offset:22528
    v_mfma_f32_32x32x16_bf16 v[160:175], v[204:207], v[128:131], v[160:175]
    buffer_load_dwordx4 v[128:131], v7, s[44:47], s58 offen offset:1024 sc1
    ds_write_b128 v13, v[100:103] offset:22528
    s_waitcnt vmcnt(9)
    v_mfma_f32_32x32x16_bf16 v[112:127], v[208:211], v[132:135], v[112:127]
    s_add_u32 s58, s42, 196608
    ds_write_b128 v14, v[104:107] offset:22528
    v_mfma_f32_32x32x16_bf16 v[160:175], v[212:215], v[132:135], v[160:175]
    buffer_load_dwordx4 v[132:135], v7, s[44:47], s58 offen offset:1024 sc1
    ds_write_b128 v15, v[108:111] offset:22528
    s_waitcnt vmcnt(9)
    v_mfma_f32_32x32x16_bf16 v[112:127], v[216:219], v[136:139], v[112:127]
    s_add_u32 s58, s42, 262144
    ds_write_b128 v16, v[144:147] offset:22528
    v_mfma_f32_32x32x16_bf16 v[160:175], v[240:243], v[136:139], v[160:175]
    buffer_load_dwordx4 v[136:139], v7, s[44:47], s58 offen offset:1024 sc1
    ds_write_b128 v17, v[148:151] offset:22528
    s_waitcnt vmcnt(9)
    v_mfma_f32_32x32x16_bf16 v[112:127], v[244:247], v[140:143], v[112:127]
    s_add_u32 s58, s43, 0
    ds_write_b128 v18, v[152:155] offset:22528
    v_mfma_f32_32x32x16_bf16 v[160:175], v[248:251], v[140:143], v[160:175]
    buffer_load_dwordx4 v[140:143], v7, s[44:47], s58 offen offset:1024 sc1
    ds_write_b128 v19, v[156:159] offset:22528
    ds_write_b32 v10, v8 offset:0
    s_waitcnt vmcnt(9)
    v_mfma_f32_32x32x16_bf16 v[112:127], v[252:255], v[220:223], v[112:127]
    s_add_u32 s58, s43, 65536
    v_mfma_f32_32x32x16_bf16 v[160:175], v[180:183], v[220:223], v[160:175]
    buffer_load_dwordx4 v[220:223], v7, s[44:47], s58 offen offset:1024 sc1
    s_waitcnt vmcnt(9)
    v_mfma_f32_32x32x16_bf16 v[112:127], v[36:39], v[224:227], v[112:127]
    s_add_u32 s58, s43, 131072
    v_mfma_f32_32x32x16_bf16 v[160:175], v[40:43], v[224:227], v[160:175]
    buffer_load_dwordx4 v[224:227], v7, s[44:47], s58 offen offset:1024 sc1
    s_waitcnt vmcnt(9)
    v_mfma_f32_32x32x16_bf16 v[112:127], v[44:47], v[80:83], v[112:127]
    s_add_u32 s58, s43, 196608
    v_mfma_f32_32x32x16_bf16 v[160:175], v[48:51], v[80:83], v[160:175]
    buffer_load_dwordx4 v[80:83], v7, s[44:47], s58 offen offset:1024 sc1
    s_waitcnt vmcnt(9)
    v_mfma_f32_32x32x16_bf16 v[112:127], v[52:55], v[84:87], v[112:127]
    ds_read_b128 v[236:239], v9 offset:0
    ds_read_b128 v[176:179], v9 offset:1024
    s_add_u32 s58, s43, 262144
    v_mfma_f32_32x32x16_bf16 v[160:175], v[24:27], v[84:87], v[160:175]
    buffer_load_dwordx4 v[84:87], v7, s[44:47], s58 offen offset:1024 sc1
    s_waitcnt vmcnt(9)
    v_mfma_f32_32x32x16_bf16 v[112:127], v[28:31], v[88:91], v[112:127]
    ds_read_b128 v[20:23], v9 offset:2048
    ds_read_b128 v[56:59], v9 offset:3072
    s_add_u32 s58, s43, 327680
    v_mfma_f32_32x32x16_bf16 v[160:175], v[32:35], v[88:91], v[160:175]
    buffer_load_dwordx4 v[88:91], v7, s[44:47], s58 offen offset:1024 sc1
    s_waitcnt vmcnt(9) lgkmcnt(2)
    v_mfma_f32_32x32x16_bf16 v[112:127], v[236:239], v[92:95], v[112:127]
    ds_read_b128 v[96:99], v9 offset:4096
    ds_read_b128 v[100:103], v9 offset:5120
    s_add_u32 s58, s43, 393216
    v_mfma_f32_32x32x16_bf16 v[160:175], v[176:179], v[92:95], v[160:175]
    buffer_load_dwordx4 v[92:95], v7, s[44:47], s58 offen offset:1024 sc1
    s_waitcnt vmcnt(9) lgkmcnt(2)
    v_mfma_f32_32x32x16_bf16 v[112:127], v[20:23], v[128:131], v[112:127]
    ds_read_b128 v[236:239], v9 offset:6144
    ds_read_b128 v[176:179], v9 offset:7168
    v_mfma_f32_32x32x16_bf16 v[160:175], v[56:59], v[128:131], v[160:175]
    s_waitcnt vmcnt(8) lgkmcnt(2)
    v_mfma_f32_32x32x16_bf16 v[112:127], v[96:99], v[132:135], v[112:127]
    ds_read_b128 v[20:23], v9 offset:8192
    ds_read_b128 v[56:59], v9 offset:9216
    v_mfma_f32_32x32x16_bf16 v[160:175], v[100:103], v[132:135], v[160:175]
    s_waitcnt vmcnt(7) lgkmcnt(2)
    v_mfma_f32_32x32x16_bf16 v[112:127], v[236:239], v[136:139], v[112:127]
    ds_read_b128 v[96:99], v9 offset:10240
    ds_read_b128 v[100:103], v9 offset:11264
    v_mfma_f32_32x32x16_bf16 v[160:175], v[176:179], v[136:139], v[160:175]
    s_waitcnt vmcnt(6) lgkmcnt(2)
    v_mfma_f32_32x32x16_bf16 v[112:127], v[20:23], v[140:143], v[112:127]
    ds_read_b128 v[236:239], v9 offset:12288
    ds_read_b128 v[176:179], v9 offset:13312
    v_mfma_f32_32x32x16_bf16 v[160:175], v[56:59], v[140:143], v[160:175]
    s_waitcnt vmcnt(5) lgkmcnt(2)
    v_mfma_f32_32x32x16_bf16 v[112:127], v[96:99], v[220:223], v[112:127]
    ds_read_b128 v[20:23], v9 offset:14336
    ds_read_b128 v[56:59], v9 offset:15360
    v_mfma_f32_32x32x16_bf16 v[160:175], v[100:103], v[220:223], v[160:175]
    s_waitcnt vmcnt(4) lgkmcnt(2)
    v_mfma_f32_32x32x16_bf16 v[112:127], v[236:239], v[224:227], v[112:127]
    ds_read_b128 v[96:99], v9 offset:16384
    ds_read_b128 v[100:103], v9 offset:17408
    v_mfma_f32_32x32x16_bf16 v[160:175], v[176:179], v[224:227], v[160:175]
    s_waitcnt vmcnt(3) lgkmcnt(2)
    v_mfma_f32_32x32x16_bf16 v[112:127], v[20:23], v[80:83], v[112:127]
    ds_read_b128 v[236:239], v9 offset:18432
    ds_read_b128 v[176:179], v9 offset:19456
    v_mfma_f32_32x32x16_bf16 v[160:175], v[56:59], v[80:83], v[160:175]
    s_waitcnt vmcnt(2) lgkmcnt(2)
    v_mfma_f32_32x32x16_bf16 v[112:127], v[96:99], v[84:87], v[112:127]
    ds_read_b128 v[20:23], v9 offset:20480
    ds_read_b128 v[56:59], v9 offset:21504
    v_mfma_f32_32x32x16_bf16 v[160:175], v[100:103], v[84:87], v[160:175]
    s_waitcnt vmcnt(1) lgkmcnt(2)
    v_mfma_f32_32x32x16_bf16 v[112:127], v[236:239], v[88:91], v[112:127]
    v_mfma_f32_32x32x16_bf16 v[160:175], v[176:179], v[88:91], v[160:175]
    s_waitcnt vmcnt(0) lgkmcnt(0)
    v_mfma_f32_32x32x16_bf16 v[112:127], v[20:23], v[92:95], v[112:127]
    v_mfma_f32_32x32x16_bf16 v[160:175], v[56:59], v[92:95], v[160:175]
    s_nop 10
    ds_write_b128 v12, v[112:115] offset:0
    ds_write_b128 v13, v[116:119] offset:0
    ds_write_b128 v14, v[120:123] offset:0
    ds_write_b128 v15, v[124:127] offset:0
    ds_write_b128 v16, v[160:163] offset:0
    ds_write_b128 v17, v[164:167] offset:0
    ds_write_b128 v18, v[168:171] offset:0
    ds_write_b128 v19, v[172:175] offset:0
    s_waitcnt lgkmcnt(0)
    s_barrier
    ds_read_b128 v[80:83], v69 offset:0
    ds_read_b128 v[84:87], v70 offset:0
    ds_read_b128 v[88:91], v69 offset:30720
    ds_read_b128 v[92:95], v70 offset:30720
    ds_read_b128 v[96:99], v74 offset:0
    ds_read_b128 v[100:103], v75 offset:0
    ds_read_b128 v[104:107], v74 offset:30720
    ds_read_b128 v[108:111], v75 offset:30720
    ds_read_b64_tr_b16 v[112:113], v71
    ds_read_b64_tr_b16 v[114:115], v71 offset:576
    v_mov_b32 v116, 0xbfb8aa3b
    v_mov_b32 v117, 1.0
    s_waitcnt lgkmcnt(6)
    v_pk_add_f32 v[80:81], v[80:81], v[88:89]
    v_pk_add_f32 v[82:83], v[82:83], v[90:91]
    v_pk_add_f32 v[84:85], v[84:85], v[92:93]
    v_pk_add_f32 v[86:87], v[86:87], v[94:95]
    s_waitcnt lgkmcnt(2)
    v_pk_add_f32 v[96:97], v[96:97], v[104:105]
    v_pk_add_f32 v[98:99], v[98:99], v[106:107]
    v_pk_add_f32 v[100:101], v[100:101], v[108:109]
    v_pk_add_f32 v[102:103], v[102:103], v[110:111]
    v_pk_add_f32 v[80:81], v[80:81], v[96:97]
    v_pk_add_f32 v[82:83], v[82:83], v[98:99]
    v_pk_add_f32 v[84:85], v[84:85], v[100:101]
    v_pk_add_f32 v[86:87], v[86:87], v[102:103]
    v_pk_mul_f32 v[88:89], v[80:81], v[116:117] op_sel_hi:[1,0]
    v_pk_mul_f32 v[90:91], v[82:83], v[116:117] op_sel_hi:[1,0]
    v_pk_mul_f32 v[92:93], v[84:85], v[116:117] op_sel_hi:[1,0]
    v_pk_mul_f32 v[94:95], v[86:87], v[116:117] op_sel_hi:[1,0]
    v_exp_f32 v88, v88
    v_exp_f32 v89, v89
    v_exp_f32 v90, v90
    v_exp_f32 v91, v91
    v_exp_f32 v92, v92
    v_exp_f32 v93, v93
    v_exp_f32 v94, v94
    v_exp_f32 v95, v95
    v_pk_add_f32 v[88:89], v[88:89], v[116:117] op_sel:[0,1] op_sel_hi:[1,1]
    v_pk_add_f32 v[90:91], v[90:91], v[116:117] op_sel:[0,1] op_sel_hi:[1,1]
    v_pk_add_f32 v[92:93], v[92:93], v[116:117] op_sel:[0,1] op_sel_hi:[1,1]
    v_pk_add_f32 v[94:95], v[94:95], v[116:117] op_sel:[0,1] op_sel_hi:[1,1]
    v_rcp_f32 v88, v88
    v_rcp_f32 v89, v89
    v_rcp_f32 v90, v90
    v_rcp_f32 v91, v91
    v_rcp_f32 v92, v92
    v_rcp_f32 v93, v93
    v_rcp_f32 v94, v94
    v_rcp_f32 v95, v95
L_fin:
    s_waitcnt lgkmcnt(0)
    v_lshlrev_b32 v96, 16, v112
    v_and_b32 v97, 0xffff0000, v112
    v_lshlrev_b32 v98, 16, v113
    v_and_b32 v99, 0xffff0000, v113
    v_lshlrev_b32 v100, 16, v114
    v_and_b32 v101, 0xffff0000, v114
    v_lshlrev_b32 v102, 16, v115
    v_and_b32 v103, 0xffff0000, v115
    v_pk_mul_f32 v[80:81], v[80:81], v[96:97]
    v_pk_mul_f32 v[82:83], v[82:83], v[98:99]
    v_pk_mul_f32 v[84:85], v[84:85], v[100:101]
    v_pk_mul_f32 v[86:87], v[86:87], v[102:103]
    v_pk_fma_f32 v[80:81], v[80:81], v[88:89], v[60:61]
    v_pk_fma_f32 v[82:83], v[82:83], v[90:91], v[62:63]
    v_pk_fma_f32 v[84:85], v[84:85], v[92:93], v[64:65]
    v_pk_fma_f32 v[86:87], v[86:87], v[94:95], v[66:67]
    v_cvt_pk_bf16_f32 v88, v80, v81
    v_cvt_pk_bf16_f32 v89, v82, v83
    v_cvt_pk_bf16_f32 v90, v84, v85
    v_cvt_pk_bf16_f32 v91, v86, v87
    global_store_dwordx4 v68, v[88:91], s[30:31]
    s_endpgm
L_idle:
    s_lshr_b32 s59, s52, 2
    s_and_b32 s58, s52, 1
    s_lshl1_add_u32 s58, s59, s58
    s_lshl2_add_u32 s58, s55, s58
    s_lshl_b32 s58, s58, 14
    s_lshl_b32 s59, s56, 7
    s_add_u32 s58, s58, s59
    s_and_b32 s59, s52, 2
    s_lshl_b32 s59, s59, 5
    s_add_u32 s58, s58, s59
    v_and_b32 v11, 15, v1
    v_lshl_add_u32 v11, v11, 10, s58
    v_and_b32 v76, 48, v1
    v_add_u32 v11, v11, v76
    v_mov_b32 v222, 0
    v_mov_b32 v223, 0
    v_mov_b32 v226, 0
    v_mov_b32 v227, 0
    v_mov_b32 v230, 0
    v_mov_b32 v231, 0
    v_mov_b32 v234, 0
    v_mov_b32 v235, 0
    v_mov_b32 v238, 0
    v_mov_b32 v239, 0
    s_mul_i32 s58, s62, 768
    s_add_u32 s58, s58, 152448
    v_lshl_add_u32 v16, v1, 2, s58
    s_xor_b32 s59, s62, 2
    v_lshl_add_u32 v15, s59, 2, v3
    s_mul_i32 s58, s59, 768
    s_add_u32 s58, s58, 152448
    v_lshl_add_u32 v17, v1, 2, s58
    s_lshl_b32 s58, s63, 10
    s_add_u32 s58, s58, 161664
    v_lshl_add_u32 v19, v18, 4, s58
    s_mov_b32 s44, s34
    s_mov_b32 s45, s35
    s_mov_b32 s46, 5636096
    s_mov_b32 s47, 0x20000
    s_lshl_b32 s58, s54, 1
    s_add_u32 s58, s58, s64
    s_mul_i32 s58, s58, 196608
    s_lshl_b32 s59, s53, 1
    s_add_u32 s59, s59, s63
    s_lshl_b32 s59, s59, 11
    s_add_u32 s58, s58, s59
    v_lshl_add_u32 v2, v1, 4, s58
    v_mov_b32 v14, 9
    s_mul_i32 s40, s56, 0
    s_mul_i32 s59, s55, 1
    s_add_u32 s40, s40, s59
    s_and_b32 s40, s40, 3
    s_cselect_b32 s59, 2, 0
    s_mul_i32 s40, s40, 5
    s_add_u32 s40, s40, s59
    s_add_u32 s41, s40, 5
    s_cmp_eq_u32 s41, 22
    s_cselect_b32 s41, 0, s41
    s_add_u32 s42, s41, 5
    s_cmp_eq_u32 s42, 22
    s_cselect_b32 s42, 0, s42
    s_add_u32 s43, s42, 5
    s_cmp_eq_u32 s43, 22
    s_cselect_b32 s43, 0, s43
    s_lshl_b32 s40, s40, 14
    s_lshl_b32 s41, s41, 14
    s_lshl_b32 s42, s42, 14
    s_lshl_b32 s43, s43, 14
    s_add_u32 s36, s34, 11534336
    s_addc_u32 s37, s35, 0
    s_mov_b32 s38, 1441792
    s_mov_b32 s39, 0x20000
    s_mul_i32 s58, s62, 360448
    s_lshl_b32 s59, s56, 11
    s_add_u32 s58, s58, s59
    v_lshl_add_u32 v18, v1, 4, s58
    s_mul_i32 s68, s62, 30720
    s_lshl_b32 s58, s2, 7
    s_add_u32 s58, s58, 10616832
    v_lshl_add_u32 v12, v1, 4, s58
    s_add_u32 s100, s100, 1
    s_add_u32 s101, s101, 1
    v_mov_b32 v240, s100
    v_mov_b32 v241, s101
    v_mov_b32 v242, s100
    v_mov_b32 v243, s101
    v_mov_b32 v13, 1
    s_mov_b32 s49, 1
    s_mov_b32 s51, 41088
    s_mov_b32 s50, 4294885120
    s_barrier
    global_load_dwordx4 v[76:79], v11, s[4:5]
    s_cmp_lg_u32 s62, 0
    s_cbranch_scc1 L_idle1
    s_mov_b64 exec, 0xff
    global_store_dwordx4 v12, v[240:243], s[34:35] sc1
    s_mov_b64 exec, -1
L_idle1:
    s_barrier
    s_barrier
    s_lshl2_add_u32 s58, s53, s62
    s_cmp_lg_u32 s58, 60
    s_cbranch_scc1 L_idle2
    v_lshlrev_b32 v36, 7, v1
    v_add_u32 v40, 10616832, v36
    v_add_u32 v41, 10625024, v36
    v_add_u32 v42, 10633216, v36
    v_add_u32 v43, 10641408, v36
    v_add_u32 v52, 10518528, v36
    v_add_u32 v53, 10526720, v36
    v_add_u32 v54, 10534912, v36
    v_add_u32 v55, 10543104, v36
    s_mov_b32 s61, 0x20000
L_mon:
    global_load_dwordx2 v[44:45], v40, s[34:35] sc1
    global_load_dwordx2 v[46:47], v41, s[34:35] sc1
    global_load_dwordx2 v[48:49], v42, s[34:35] sc1
    global_load_dwordx2 v[50:51], v43, s[34:35] sc1
    s_sub_u32 s61, s61, 1
    s_cbranch_scc1 L_mond
    s_waitcnt vmcnt(0)
    v_xor_b32 v44, v44, v240
    v_xor_b32 v45, v45, v241
    v_xor_b32 v46, v46, v240
    v_xor_b32 v47, v47, v241
    v_xor_b32 v48, v48, v240
    v_xor_b32 v49, v49, v241
    v_xor_b32 v50, v50, v240
    v_xor_b32 v51, v51, v241
    v_or3_b32 v44, v44, v45, v46
    v_or3_b32 v44, v44, v47, v48
    v_or3_b32 v44, v44, v49, v50
    v_or_b32 v44, v44, v51
    v_cmp_ne_u32 vcc, 0, v44
    s_nop 1
    s_cbranch_vccnz L_mon
L_mond:
    global_atomic_add v52, v13, s[34:35] sc1
    global_atomic_add v53, v13, s[34:35] sc1
    global_atomic_add v54, v13, s[34:35] sc1
    global_atomic_add v55, v13, s[34:35] sc1
    v_mov_b32 v37, 10649600
    s_mov_b64 exec, 1
    global_store_dwordx2 v37, v[240:241], s[34:35] sc1
    s_mov_b64 exec, -1
L_idle2:
    s_barrier
    s_barrier
    s_barrier
    s_barrier
    s_mov_b32 s61, 0x100000
L_w10:
    ds_read_b128 v[4:7], v3 offset:16
    s_sub_u32 s61, s61, 1
    s_waitcnt lgkmcnt(0)
    v_min3_u32 v4, v4, v5, v6
    v_min_u32 v4, v4, v7
    s_nop 0
    v_readfirstlane_b32 s60, v4
    s_cbranch_scc1 L_w10d
    s_cmp_lt_u32 s60, 1
    s_cbranch_scc1 L_w10
L_w10d:
    s_add_u32 s59, s40, 0
    buffer_load_dwordx4 v[184:187], v18, s[36:39], s59 offen offset:0 sc1
    buffer_load_dwordx4 v[188:191], v18, s[36:39], s59 offen offset:1024 sc1
    s_add_u32 s59, s40, 16384
    buffer_load_dwordx4 v[192:195], v18, s[36:39], s59 offen offset:0 sc1
    buffer_load_dwordx4 v[196:199], v18, s[36:39], s59 offen offset:1024 sc1
    s_add_u32 s59, s40, 32768
    buffer_load_dwordx4 v[200:203], v18, s[36:39], s59 offen offset:0 sc1
    buffer_load_dwordx4 v[204:207], v18, s[36:39], s59 offen offset:1024 sc1
    s_add_u32 s59, s40, 49152
    buffer_load_dwordx4 v[208:211], v18, s[36:39], s59 offen offset:0 sc1
    buffer_load_dwordx4 v[212:215], v18, s[36:39], s59 offen offset:1024 sc1
    s_add_u32 s59, s40, 65536
    buffer_load_dwordx4 v[216:219], v18, s[36:39], s59 offen offset:0 sc1
    buffer_load_dwordx4 v[240:243], v18, s[36:39], s59 offen offset:1024 sc1
    s_add_u32 s59, s41, 0
    buffer_load_dwordx4 v[244:247], v18, s[36:39], s59 offen offset:0 sc1
    buffer_load_dwordx4 v[248:251], v18, s[36:39], s59 offen offset:1024 sc1
    s_add_u32 s59, s41, 16384
    buffer_load_dwordx4 v[252:255], v18, s[36:39], s59 offen offset:0 sc1
    buffer_load_dwordx4 v[180:183], v18, s[36:39], s59 offen offset:1024 sc1
    s_waitcnt vmcnt(0)
    s_branch L_g2
L_exit:
    s_endpgm
.section .rodata,"a"
.p2align 6
.amdhsa_kernel recurrent_scan__ssm_conv_s4__glu_gated_glu__prompt_kernel
  .amdhsa_next_free_vgpr 256
  .amdhsa_next_free_sgpr 102
  .amdhsa_accum_offset 256
  .amdhsa_group_segment_fixed_size 0
  .amdhsa_kernarg_size 128
  .amdhsa_user_sgpr_count 2
  .amdhsa_user_sgpr_kernarg_segment_ptr 1
  .amdhsa_system_sgpr_workgroup_id_x 1
.end_amdhsa_kernel
```
